```python
import torch

def _softmax(x, axis=-1):
    return torch.softmax(x, dim=axis)
def _gelu(x):
    return torch.nn.functional.gelu(x, approximate="tanh")
def _silu(x):
    return torch.nn.functional.silu(x)
def _sigmoid(x):
    return torch.sigmoid(x)
def _layernorm(x, axis=-1, eps=1e-5):
    m = x.mean(dim=axis, keepdim=True)
    v = x.var(dim=axis, keepdim=True, unbiased=False)
    return (x - m) / torch.sqrt(v + eps)
def _scatter_add(tgt, idx, src, axis=0):
    return tgt.clone().index_add_(axis, idx, src)
def _segment_sum(src, seg, n):
    out = torch.zeros((n,) + src.shape[1:], dtype=src.dtype)
    return out.index_add_(0, seg, src)
def _pad(x, pw):
    flat = tuple(v for pair in reversed(pw) for v in pair)
    return torch.nn.functional.pad(x, flat)

kernel_name = 'recurrent_scan__sliding_block_cached__geglu_ffn__decode'

def setup_inputs():

    _w = (lambda a: (lambda t: t.to(torch.bfloat16) if t.is_floating_point() else t)(torch.as_tensor(a)))
    def _A_setup():
        B, Sq, D = 1, 1, 512
        Hq, Hkv, Sk, Dh = 32, 8, 32768, 128
        assert Hq % Hkv == 0, (Hq, Hkv)
        return {
            "x": _w((lambda *s: torch.randn(*s, dtype=torch.bfloat16) * 0.05)(B, Sq, D)),
            "k_cache": _w((lambda *s: torch.randn(*s, dtype=torch.bfloat16) * 1.6)(B, Hkv, Sk, Dh)),
            "v_cache": _w((lambda *s: torch.randn(*s, dtype=torch.bfloat16) * 0.2)(B, Hkv, Sk, Dh)),
            "wq": _w((lambda *s: torch.randn(*s, dtype=torch.bfloat16) * 1.6)(D, Hq * Dh) * (D ** -0.5)),
            "wo": _w((lambda *s: torch.randn(*s, dtype=torch.bfloat16) * 0.2)(Hq * Dh, D) * ((Hq * Dh) ** -0.5)),
        }
    _A_in = _A_setup()

    def _B_setup():
        B, S, D, F = 1, 1, 512, 1792
        return {
            "x": _w((lambda *s: torch.randn(*s, dtype=torch.bfloat16) * 0.05)(B, S, D)),
            "w_gate": _w((lambda *s: torch.randn(*s, dtype=torch.bfloat16) * 0.1)(D, F)),
            "w_up": _w((lambda *s: torch.randn(*s, dtype=torch.bfloat16) * 0.1)(D, F)),
            "w_down": _w((lambda *s: torch.randn(*s, dtype=torch.bfloat16) * 0.1)(F, D)),
        }
    _B_in = _B_setup()

    return {
        "A_x": _A_in["x"],
        "A_k_cache": _A_in["k_cache"],
        "A_v_cache": _A_in["v_cache"],
        "A_wq": _A_in["wq"],
        "A_wo": _A_in["wo"],
        "B_x": _B_in["x"],
        "B_w_gate": _B_in["w_gate"],
        "B_w_up": _B_in["w_up"],
        "B_w_down": _B_in["w_down"],
    }

def reference(A_x, A_k_cache, A_v_cache, A_wq, A_wo, B_x, B_w_gate, B_w_up, B_w_down):
    def _A_ref(x, k_cache, v_cache, wq, wo):
        B, Sq, D = x.shape
        Hq, Dh = 32, 128
        Hkv, Sk = k_cache.shape[1], k_cache.shape[2]
        W = min(4096, max(256, Sk // 4))
        rep = Hq // Hkv
        q = (lambda x, *d: x.permute(*d))((x @ wq).reshape(B, Sq, Hq, Dh), 0, 2, 1, 3)
        k = (lambda x, n, axis: torch.repeat_interleave(x, n, dim=axis))(k_cache[:, :, Sk - W:, :], rep, axis=1)
        v = (lambda x, n, axis: torch.repeat_interleave(x, n, dim=axis))(v_cache[:, :, Sk - W:, :], rep, axis=1)
        scores = torch.einsum("bhqd,bhkd->bhqk", q, k) * (Dh ** -0.5)
        p = _softmax(scores, axis=-1)
        o = torch.einsum("bhqk,bhkd->bhqd", p, v)
        return (lambda x, *d: x.permute(*d))(o, 0, 2, 1, 3).reshape(B, Sq, Hq * Dh) @ wo

    def _B_ref(x, w_gate, w_up, w_down):
        return (_gelu(x @ w_gate) * (x @ w_up)) @ w_down

    x = A_x
    xn = _layernorm(x, axis=-1)
    s = _A_ref(xn, A_k_cache, A_v_cache, A_wq, A_wo)
    g = _silu(_B_ref(xn, B_w_gate, B_w_up, B_w_down))
    return x + s * g
```

```asm
; @launch grid=(256,1,1) block=(512,1,1) lds=134144
.amdgcn_target "amdgcn-amd-amdhsa--gfx950"
.text
.globl recurrent_scan__sliding_block_cached__geglu_ffn__decode_kernel
.p2align 13
.type recurrent_scan__sliding_block_cached__geglu_ffn__decode_kernel,@function
recurrent_scan__sliding_block_cached__geglu_ffn__decode_kernel:
    s_getpc_b64 s[40:41]
L_pc:
    s_cmp_ge_u32 s2, 256
    s_cbranch_scc1 L_exit
    s_load_dwordx16 s[8:23], s[0:1], 0
    s_load_dwordx8 s[24:31], s[0:1], 64
    s_bfe_u32 s42, s2, 196611
    v_xor_b32 v1, 0x1ff, v0
    s_lshl_b32 s42, s42, 7
    v_lshl_add_u32 v1, v1, 10, s42
    v_cmp_gt_u32 vcc, L_exit-L_pc+512, v1
    v_lshlrev_b32 v2, 2, v0
    v_mov_b32 v3, 0
    s_and_saveexec_b64 s[42:43], vcc
    s_cbranch_execz L_nopf
    global_load_dword v127, v1, s[40:41]
L_nopf:
    s_mov_b64 exec, -1
    ds_write_b32 v2, v3
    v_lshrrev_b32 v1, 6, v0
    v_and_b32 v0, 63, v0
    v_readfirstlane_b32 s5, v1
    s_and_b32 s3, s2, 7
    s_lshr_b32 s4, s2, 3
    s_xor_b32 s4, s4, 0
    s_lshr_b32 s6, s4, 3
    s_and_b32 s7, s4, 7
    v_lshlrev_b32 v63, 2, v0
    v_mov_b32 v62, 0xfffff000
    v_lshlrev_b32 v60, 4, v0
    s_lshl2_add_u32 s35, s3, s6
    s_min_u32 s34, s3, 1
    s_sub_u32 s35, s35, 4
    s_cmp_eq_u32 s5, 0
    s_cbranch_scc1 L_loader
    s_mul_i32 s36, s3, 110592
    s_add_u32 s36, s36, 4096
    s_mul_i32 s37, s4, 3456
    s_add_u32 s37, s37, s36
    s_cmp_eq_u32 s5, 1
    s_waitcnt lgkmcnt(0)
    s_cbranch_scc0 L_disp
    global_load_dwordx4 v[4:7], v60, s[8:9]
    s_load_dword s32, s[30:31], 0
    s_add_u32 s48, s30, 1048576
    s_addc_u32 s49, s31, 0
    s_barrier
    s_branch L_q
L_disp:
    s_add_u32 s48, s30, 1048576
    s_addc_u32 s49, s31, 0
    s_cmp_eq_u32 s5, 3
    s_cbranch_scc1 L_w3
    s_cmp_eq_u32 s5, 2
    s_cbranch_scc1 L_ffn
    s_barrier
    s_branch L_kv
L_loader:
    s_setprio 3
    v_lshrrev_b32 v2, 3, v0
    v_and_b32 v3, 7, v0
    v_lshlrev_b32 v3, 4, v3
    s_lshl_b32 s40, s6, 20
    s_lshl_b32 s41, s7, 7
    s_add_u32 s40, s40, s41
    s_lshl_b32 s42, s3, 10
    s_add_u32 s40, s40, s42
    v_lshlrev_b32 v10, 13, v2
    v_add3_u32 v10, v10, v3, s40
    v_mov_b32 v20, 64
    s_mov_b32 m0, 10752
    s_mov_b32 s38, 65536
    s_waitcnt lgkmcnt(0)
L_ld_q0:
    global_load_lds_dwordx4 v10, s[14:15] nt
    s_addk_i32 m0, 1024
    v_add_u32 v10, s38, v10
    global_load_lds_dwordx4 v10, s[14:15] nt
    s_addk_i32 m0, 1024
    v_add_u32 v10, s38, v10
    global_load_lds_dwordx4 v10, s[14:15] nt
    s_addk_i32 m0, 1024
    v_add_u32 v10, s38, v10
    global_load_lds_dwordx4 v10, s[14:15] nt
    s_addk_i32 m0, 1024
    v_add_u32 v10, s38, v10
    s_cmp_lg_u32 m0, 27136
    s_cbranch_scc1 L_ld_q0
    v_add_u32 v20, 16, v20
    s_barrier
    s_mul_i32 s40, s7, 229376
    s_lshl_b32 s42, s35, 7
    s_add_u32 s40, s40, s42
    v_mul_u32_u24 v11, 3584, v2
    v_add3_u32 v11, v11, v3, s40
    v_mov_b32 v12, v11
    s_lshl_b32 s40, s3, 23
    s_lshl_b32 s42, s4, 10
    s_add_u32 s40, s40, s42
    s_add_u32 s40, s40, 7340032
    v_lshl_add_u32 v14, v0, 4, s40
    v_lshrrev_b32 v4, 4, v0
    v_lshlrev_b32 v4, 6, v4
    v_xor_b32 v13, v14, v4
    v_mov_b32 v14, v13
    s_lshl_b32 s40, s35, 16
    s_add_u32 s40, s40, s41
    v_lshlrev_b32 v15, 10, v2
    v_add3_u32 v15, v15, v3, s40
    s_lshl_b32 s40, s3, 19
    s_lshl_b32 s42, s6, 17
    s_add_u32 s40, s40, s42
    s_add_u32 s40, s40, s41
    v_and_b32 v4, 32, v0
    v_xor_b32 v4, v4, v3
    v_lshlrev_b32 v16, 10, v2
    v_add3_u32 v16, v16, v4, s40
    s_movk_i32 s46, -20
    s_movk_i32 s45, 80
    s_mov_b32 s43, 0
    s_lshl_b32 s47, s3, 2
    s_lshr_b32 s47, 0x12242200, s47
    s_and_b32 s47, s47, 15
    s_cmp_eq_u32 s34, 0
    s_cbranch_scc0 L_ld_ffn
    s_mov_b32 m0, 43520
    s_mov_b32 s38, 0
    s_cmp_eq_u32 s7, 3
    s_cselect_b32 s44, 14, 12
L_ld_k0n:
    s_getreg_b32 s54, hwreg(HW_REG_IB_STS)
    s_add_u32 s46, s46, 8
    s_and_b32 s55, s54, 15
    s_bfe_u32 s54, s54, 0x20016
    s_lshl4_add_u32 s54, s54, s55
    s_sub_u32 s55, s45, s54
    s_cmp_eq_u32 s55, s43
    s_cbranch_scc1 L_ld_k0n_same
    v_mov_b32 v21, s55
    s_mov_b32 s43, s55
    ds_write_b32 v63, v21 offset:0
L_ld_k0n_same:
    s_cmp_le_u32 s54, s44
    s_cbranch_scc1 L_ld_k0n_go
    s_cmp_lt_i32 s46, 0
    s_cbranch_scc1 L_ld_k0n
    s_cmp_le_u32 s54, 28
    s_cbranch_scc0 L_ld_k0n
L_ld_k0n_go:
    s_sub_u32 s46, s46, 20
    s_add_u32 s45, s45, 4
    s_max_i32 s46, s46, -20
    v_xor_b32 v17, s38, v13
    global_load_lds_dwordx4 v17, s[10:11] nt
    s_addk_i32 m0, 1040
    s_add_u32 s38, s38, 0x8400
    v_xor_b32 v17, s38, v13
    global_load_lds_dwordx4 v17, s[10:11] nt
    s_addk_i32 m0, 1040
    s_add_u32 s38, s38, 0x8400
    v_xor_b32 v17, s38, v13
    global_load_lds_dwordx4 v17, s[10:11] nt
    s_addk_i32 m0, 1040
    s_add_u32 s38, s38, 0x8400
    v_xor_b32 v17, s38, v13
    global_load_lds_dwordx4 v17, s[10:11] nt
    s_addk_i32 m0, 1040
    s_add_u32 s38, s38, 0x8400
    s_cmp_lg_u32 m0, 76800
    s_cbranch_scc1 L_ld_k0n
    s_mov_b32 m0, 76800
    s_mov_b32 s38, 0
    s_cmp_eq_u32 s7, 3
    s_cselect_b32 s44, 14, 12
L_ld_v0n:
    s_getreg_b32 s54, hwreg(HW_REG_IB_STS)
    s_add_u32 s46, s46, 8
    s_and_b32 s55, s54, 15
    s_bfe_u32 s54, s54, 0x20016
    s_lshl4_add_u32 s54, s54, s55
    s_sub_u32 s55, s45, s54
    s_cmp_eq_u32 s55, s43
    s_cbranch_scc1 L_ld_v0n_same
    v_mov_b32 v21, s55
    s_mov_b32 s43, s55
    ds_write_b32 v63, v21 offset:0
L_ld_v0n_same:
    s_cmp_le_u32 s54, s44
    s_cbranch_scc1 L_ld_v0n_go
    s_cmp_lt_i32 s46, 0
    s_cbranch_scc1 L_ld_v0n
    s_cmp_le_u32 s54, 28
    s_cbranch_scc0 L_ld_v0n
L_ld_v0n_go:
    s_sub_u32 s46, s46, 20
    s_add_u32 s45, s45, 4
    s_max_i32 s46, s46, -20
    v_xor_b32 v17, s38, v14
    global_load_lds_dwordx4 v17, s[12:13] nt
    s_addk_i32 m0, 1024
    s_add_u32 s38, s38, 0x8400
    v_xor_b32 v17, s38, v14
    global_load_lds_dwordx4 v17, s[12:13] nt
    s_addk_i32 m0, 1024
    s_add_u32 s38, s38, 0x8400
    v_xor_b32 v17, s38, v14
    global_load_lds_dwordx4 v17, s[12:13] nt
    s_addk_i32 m0, 1024
    s_add_u32 s38, s38, 0x8400
    v_xor_b32 v17, s38, v14
    global_load_lds_dwordx4 v17, s[12:13] nt
    s_addk_i32 m0, 1024
    s_add_u32 s38, s38, 0x8400
    s_cmp_lg_u32 m0, 109568
    s_cbranch_scc1 L_ld_v0n
    s_mov_b32 m0, 117760
    s_mov_b32 s38, 8192
    s_cmp_eq_u32 s7, 3
    s_cselect_b32 s44, 10, 8
L_ld_o0n:
    s_getreg_b32 s54, hwreg(HW_REG_IB_STS)
    s_add_u32 s46, s46, 8
    s_and_b32 s55, s54, 15
    s_bfe_u32 s54, s54, 0x20016
    s_lshl4_add_u32 s54, s54, s55
    s_sub_u32 s55, s45, s54
    s_cmp_eq_u32 s55, s43
    s_cbranch_scc1 L_ld_o0n_same
    v_mov_b32 v21, s55
    s_mov_b32 s43, s55
    ds_write_b32 v63, v21 offset:0
L_ld_o0n_same:
    s_cmp_le_u32 s54, s44
    s_cbranch_scc1 L_ld_o0n_go
    s_cmp_lt_i32 s46, 0
    s_cbranch_scc1 L_ld_o0n
    s_cmp_le_u32 s54, 28
    s_cbranch_scc0 L_ld_o0n
L_ld_o0n_go:
    s_sub_u32 s46, s46, 20
    s_add_u32 s45, s45, 4
    s_max_i32 s46, s46, -20
    global_load_lds_dwordx4 v16, s[16:17] nt
    s_addk_i32 m0, 1024
    v_add_u32 v16, s38, v16
    global_load_lds_dwordx4 v16, s[16:17] nt
    s_addk_i32 m0, 1024
    v_add_u32 v16, s38, v16
    global_load_lds_dwordx4 v16, s[16:17] nt
    s_addk_i32 m0, 1024
    v_add_u32 v16, s38, v16
    global_load_lds_dwordx4 v16, s[16:17] nt
    s_addk_i32 m0, 1024
    v_add_u32 v16, s38, v16
    v_xor_b32 v16, 64, v16
    s_cmp_lg_u32 m0, 134144
    s_cbranch_scc1 L_ld_o0n
    s_branch L_ld_drain2
L_ld_ffn:
    s_cmp_eq_u32 s34, 0
    s_cbranch_scc1 L_skip_g
    s_mov_b32 m0, 27136
    s_mov_b32 s38, 28672
    s_cmp_eq_u32 s7, 3
    s_cselect_b32 s44, 17, 15
    s_add_u32 s44, s44, s47
L_ld_g0:
    s_getreg_b32 s54, hwreg(HW_REG_IB_STS)
    s_add_u32 s46, s46, 8
    s_and_b32 s55, s54, 15
    s_bfe_u32 s54, s54, 0x20016
    s_lshl4_add_u32 s54, s54, s55
    s_sub_u32 s55, s45, s54
    s_cmp_eq_u32 s55, s43
    s_cbranch_scc1 L_ld_g0_same
    v_mov_b32 v21, s55
    s_mov_b32 s43, s55
    ds_write_b32 v63, v21 offset:0
L_ld_g0_same:
    s_cmp_le_u32 s54, s44
    s_cbranch_scc1 L_ld_g0_go
    s_cmp_lt_i32 s46, 0
    s_cbranch_scc1 L_ld_g0
    s_cmp_le_u32 s54, 28
    s_cbranch_scc0 L_ld_g0
L_ld_g0_go:
    s_sub_u32 s46, s46, 20
    s_add_u32 s45, s45, 4
    s_max_i32 s46, s46, -20
    global_load_lds_dwordx4 v11, s[20:21] nt
    s_addk_i32 m0, 1024
    v_add_u32 v11, s38, v11
    global_load_lds_dwordx4 v11, s[20:21] nt
    s_addk_i32 m0, 1024
    v_add_u32 v11, s38, v11
    global_load_lds_dwordx4 v11, s[20:21] nt
    s_addk_i32 m0, 1024
    v_add_u32 v11, s38, v11
    global_load_lds_dwordx4 v11, s[20:21] nt
    s_addk_i32 m0, 1024
    v_add_u32 v11, s38, v11
    s_cmp_lg_u32 m0, 35328
    s_cbranch_scc1 L_ld_g0
    s_mov_b32 s38, 28672
L_ld_g1:
    s_getreg_b32 s54, hwreg(HW_REG_IB_STS)
    s_add_u32 s46, s46, 8
    s_and_b32 s55, s54, 15
    s_bfe_u32 s54, s54, 0x20016
    s_lshl4_add_u32 s54, s54, s55
    s_sub_u32 s55, s45, s54
    s_cmp_eq_u32 s55, s43
    s_cbranch_scc1 L_ld_g1_same
    v_mov_b32 v21, s55
    s_mov_b32 s43, s55
    ds_write_b32 v63, v21 offset:0
L_ld_g1_same:
    s_cmp_le_u32 s54, s44
    s_cbranch_scc1 L_ld_g1_go
    s_cmp_lt_i32 s46, 0
    s_cbranch_scc1 L_ld_g1
    s_cmp_le_u32 s54, 28
    s_cbranch_scc0 L_ld_g1
L_ld_g1_go:
    s_sub_u32 s46, s46, 20
    s_add_u32 s45, s45, 4
    s_max_i32 s46, s46, -20
    global_load_lds_dwordx4 v12, s[22:23] nt
    s_addk_i32 m0, 1024
    v_add_u32 v12, s38, v12
    global_load_lds_dwordx4 v12, s[22:23] nt
    s_addk_i32 m0, 1024
    v_add_u32 v12, s38, v12
    global_load_lds_dwordx4 v12, s[22:23] nt
    s_addk_i32 m0, 1024
    v_add_u32 v12, s38, v12
    global_load_lds_dwordx4 v12, s[22:23] nt
    s_addk_i32 m0, 1024
    v_add_u32 v12, s38, v12
    s_cmp_lg_u32 m0, 43520
    s_cbranch_scc1 L_ld_g1
L_skip_g:
    s_mov_b32 m0, 43520
    s_mov_b32 s38, 0
    s_cmp_eq_u32 s7, 3
    s_cselect_b32 s44, 17, 15
    s_add_u32 s44, s44, s47
L_ld_k0:
    s_getreg_b32 s54, hwreg(HW_REG_IB_STS)
    s_add_u32 s46, s46, 8
    s_and_b32 s55, s54, 15
    s_bfe_u32 s54, s54, 0x20016
    s_lshl4_add_u32 s54, s54, s55
    s_sub_u32 s55, s45, s54
    s_cmp_eq_u32 s55, s43
    s_cbranch_scc1 L_ld_k0_same
    v_mov_b32 v21, s55
    s_mov_b32 s43, s55
    ds_write_b32 v63, v21 offset:0
L_ld_k0_same:
    s_cmp_le_u32 s54, s44
    s_cbranch_scc1 L_ld_k0_go
    s_cmp_lt_i32 s46, 0
    s_cbranch_scc1 L_ld_k0
    s_cmp_le_u32 s54, 28
    s_cbranch_scc0 L_ld_k0
L_ld_k0_go:
    s_sub_u32 s46, s46, 20
    s_add_u32 s45, s45, 4
    s_max_i32 s46, s46, -20
    v_xor_b32 v17, s38, v13
    global_load_lds_dwordx4 v17, s[10:11] nt
    s_addk_i32 m0, 1040
    s_add_u32 s38, s38, 0x8400
    v_xor_b32 v17, s38, v13
    global_load_lds_dwordx4 v17, s[10:11] nt
    s_addk_i32 m0, 1040
    s_add_u32 s38, s38, 0x8400
    v_xor_b32 v17, s38, v13
    global_load_lds_dwordx4 v17, s[10:11] nt
    s_addk_i32 m0, 1040
    s_add_u32 s38, s38, 0x8400
    v_xor_b32 v17, s38, v13
    global_load_lds_dwordx4 v17, s[10:11] nt
    s_addk_i32 m0, 1040
    s_add_u32 s38, s38, 0x8400
    s_cmp_lg_u32 m0, 76800
    s_cbranch_scc1 L_ld_k0
    s_mov_b32 m0, 76800
    s_mov_b32 s38, 0
    s_cmp_eq_u32 s7, 3
    s_cselect_b32 s44, 17, 15
    s_add_u32 s44, s44, s47
L_ld_v0:
    s_getreg_b32 s54, hwreg(HW_REG_IB_STS)
    s_add_u32 s46, s46, 8
    s_and_b32 s55, s54, 15
    s_bfe_u32 s54, s54, 0x20016
    s_lshl4_add_u32 s54, s54, s55
    s_sub_u32 s55, s45, s54
    s_cmp_eq_u32 s55, s43
    s_cbranch_scc1 L_ld_v0_same
    v_mov_b32 v21, s55
    s_mov_b32 s43, s55
    ds_write_b32 v63, v21 offset:0
L_ld_v0_same:
    s_cmp_le_u32 s54, s44
    s_cbranch_scc1 L_ld_v0_go
    s_cmp_lt_i32 s46, 0
    s_cbranch_scc1 L_ld_v0
    s_cmp_le_u32 s54, 28
    s_cbranch_scc0 L_ld_v0
L_ld_v0_go:
    s_sub_u32 s46, s46, 20
    s_add_u32 s45, s45, 4
    s_max_i32 s46, s46, -20
    v_xor_b32 v17, s38, v14
    global_load_lds_dwordx4 v17, s[12:13] nt
    s_addk_i32 m0, 1024
    s_add_u32 s38, s38, 0x8400
    v_xor_b32 v17, s38, v14
    global_load_lds_dwordx4 v17, s[12:13] nt
    s_addk_i32 m0, 1024
    s_add_u32 s38, s38, 0x8400
    v_xor_b32 v17, s38, v14
    global_load_lds_dwordx4 v17, s[12:13] nt
    s_addk_i32 m0, 1024
    s_add_u32 s38, s38, 0x8400
    v_xor_b32 v17, s38, v14
    global_load_lds_dwordx4 v17, s[12:13] nt
    s_addk_i32 m0, 1024
    s_add_u32 s38, s38, 0x8400
    s_cmp_lg_u32 m0, 109568
    s_cbranch_scc1 L_ld_v0
    s_cmp_eq_u32 s34, 0
    s_cbranch_scc1 L_skip_d
    s_mov_b32 m0, 109568
    s_mov_b32 s38, 8192
    s_cmp_eq_u32 s7, 3
    s_cselect_b32 s44, 13, 11
    s_add_u32 s44, s44, s47
L_ld_d0:
    s_getreg_b32 s54, hwreg(HW_REG_IB_STS)
    s_add_u32 s46, s46, 8
    s_and_b32 s55, s54, 15
    s_bfe_u32 s54, s54, 0x20016
    s_lshl4_add_u32 s54, s54, s55
    s_sub_u32 s55, s45, s54
    s_cmp_eq_u32 s55, s43
    s_cbranch_scc1 L_ld_d0_same
    v_mov_b32 v21, s55
    s_mov_b32 s43, s55
    ds_write_b32 v63, v21 offset:0
L_ld_d0_same:
    s_cmp_le_u32 s54, s44
    s_cbranch_scc1 L_ld_d0_go
    s_cmp_lt_i32 s46, 0
    s_cbranch_scc1 L_ld_d0
    s_cmp_le_u32 s54, 28
    s_cbranch_scc0 L_ld_d0
L_ld_d0_go:
    s_sub_u32 s46, s46, 20
    s_add_u32 s45, s45, 4
    s_max_i32 s46, s46, -20
    global_load_lds_dwordx4 v15, s[24:25] nt
    s_addk_i32 m0, 1024
    v_add_u32 v15, s38, v15
    global_load_lds_dwordx4 v15, s[24:25] nt
    s_addk_i32 m0, 1024
    v_add_u32 v15, s38, v15
    global_load_lds_dwordx4 v15, s[24:25] nt
    s_addk_i32 m0, 1024
    v_add_u32 v15, s38, v15
    global_load_lds_dwordx4 v15, s[24:25] nt
    s_addk_i32 m0, 1024
    v_add_u32 v15, s38, v15
    s_cmp_lg_u32 m0, 117760
    s_cbranch_scc1 L_ld_d0
L_skip_d:
    s_mov_b32 m0, 117760
    s_mov_b32 s38, 8192
    s_cmp_eq_u32 s7, 3
    s_cselect_b32 s44, 13, 11
    s_add_u32 s44, s44, s47
L_ld_o0:
    s_getreg_b32 s54, hwreg(HW_REG_IB_STS)
    s_add_u32 s46, s46, 8
    s_and_b32 s55, s54, 15
    s_bfe_u32 s54, s54, 0x20016
    s_lshl4_add_u32 s54, s54, s55
    s_sub_u32 s55, s45, s54
    s_cmp_eq_u32 s55, s43
    s_cbranch_scc1 L_ld_o0_same
    v_mov_b32 v21, s55
    s_mov_b32 s43, s55
    ds_write_b32 v63, v21 offset:0
L_ld_o0_same:
    s_cmp_le_u32 s54, s44
    s_cbranch_scc1 L_ld_o0_go
    s_cmp_lt_i32 s46, 0
    s_cbranch_scc1 L_ld_o0
    s_cmp_le_u32 s54, 28
    s_cbranch_scc0 L_ld_o0
L_ld_o0_go:
    s_sub_u32 s46, s46, 20
    s_add_u32 s45, s45, 4
    s_max_i32 s46, s46, -20
    global_load_lds_dwordx4 v16, s[16:17] nt
    s_addk_i32 m0, 1024
    v_add_u32 v16, s38, v16
    global_load_lds_dwordx4 v16, s[16:17] nt
    s_addk_i32 m0, 1024
    v_add_u32 v16, s38, v16
    global_load_lds_dwordx4 v16, s[16:17] nt
    s_addk_i32 m0, 1024
    v_add_u32 v16, s38, v16
    global_load_lds_dwordx4 v16, s[16:17] nt
    s_addk_i32 m0, 1024
    v_add_u32 v16, s38, v16
    v_xor_b32 v16, 64, v16
    s_cmp_lg_u32 m0, 134144
    s_cbranch_scc1 L_ld_o0
L_ld_drain2:
L_ld_dr:
    s_getreg_b32 s54, hwreg(HW_REG_IB_STS)
    s_and_b32 s55, s54, 15
    s_bfe_u32 s54, s54, 0x20016
    s_lshl4_add_u32 s54, s54, s55
    s_sub_u32 s55, s45, s54
    v_mov_b32 v21, s55
    ds_write_b32 v63, v21 offset:0
    s_waitcnt lgkmcnt(0)
    s_cmp_lg_u32 s54, 0
    s_cbranch_scc1 L_ld_dr
    s_branch L_finish
L_q:
    s_setprio 2
    s_getreg_b32 s38, hwreg(HW_REG_XCC_ID, 0, 3)
    s_bitset1_b32 s38, 20
    v_bfe_u32 v16, v0, 1, 1
    v_lshlrev_b32 v16, 4, v16
    v_mov_b32 v17, 0xffff
    v_lshlrev_b32 v16, v16, v17
    v_bfe_u32 v17, v0, 2, 2
    v_cmp_eq_u32 vcc, 0, v17
    s_nop 1
    v_cndmask_b32 v24, 0, v16, vcc
    v_cmp_eq_u32 vcc, 1, v17
    s_nop 1
    v_cndmask_b32 v25, 0, v16, vcc
    v_cmp_eq_u32 vcc, 2, v17
    s_nop 1
    v_cndmask_b32 v26, 0, v16, vcc
    v_cmp_eq_u32 vcc, 3, v17
    s_nop 1
    v_cndmask_b32 v27, 0, v16, vcc
    v_lshrrev_b32 v3, 4, v0
    v_and_b32 v16, 1, v0
    v_lshl_add_u32 v3, v3, 1, v16
    s_lshl_b32 s40, s6, 6
    s_add_u32 s40, s40, 6272
    v_mul_u32_u24 v61, 272, v3
    v_add_u32 v61, s40, v61
    v_mov_b32 v59, 0x3f803f80
    v_lshrrev_b32 v1, 5, v0
    v_and_b32 v2, 7, v0
    v_lshlrev_b32 v2, 4, v2
    v_lshl_add_u32 v1, v1, 7, v2
    s_add_u32 s40, s37, 2560
    v_add_u32 v58, s40, v1
    v_add_u32 v2, s37, v60
    v_mov_b32 v52, -1
    v_mov_b32 v53, -1
    v_mov_b32 v54, -1
    v_mov_b32 v55, -1
    global_store_dwordx4 v2, v[52:55], s[48:49]
    v_mov_b32 v48, 0x800
    v_mov_b32 v49, 0x800
    v_mov_b32 v50, 0x800
    v_mov_b32 v51, 0x800
    s_mov_b32 exec_lo, 0xff
    s_mov_b32 exec_hi, 0xff
    global_store_dwordx4 v58, v[48:51], s[48:49]
    s_mov_b32 exec_lo, 0x1
    s_mov_b32 exec_hi, 0x1
    global_load_dword v56, v58, s[48:49] nt
    s_mov_b64 exec, -1
    s_mov_b32 exec_lo, 0x01010101
    s_mov_b32 exec_hi, 0x01010101
    global_load_dword v56, v2, s[48:49] nt
    s_mov_b64 exec, -1
    s_waitcnt vmcnt(4)
    v_dot2_f32_bf16 v16, v4, v59, 0
    v_dot2_f32_bf16 v17, v4, v4, 0
    v_dot2_f32_bf16 v18, v5, v59, 0
    v_dot2_f32_bf16 v19, v5, v5, 0
    v_dot2_f32_bf16 v16, v6, v59, v16
    v_dot2_f32_bf16 v17, v6, v6, v17
    v_dot2_f32_bf16 v18, v7, v59, v18
    v_dot2_f32_bf16 v19, v7, v7, v19
    v_lshlrev_b32 v8, 16, v4
    v_and_b32 v9, 0xffff0000, v4
    v_add_f32 v16, v16, v18
    v_add_f32 v17, v17, v19
    v_lshlrev_b32 v10, 16, v5
    v_and_b32 v11, 0xffff0000, v5
    v_permlane32_swap_b32 v16, v17
    v_add_f32 v16, v16, v17
    v_lshlrev_b32 v12, 16, v6
    v_and_b32 v13, 0xffff0000, v6
    v_add_f32_dpp v16, v16, v16 row_ror:1 row_mask:0xf bank_mask:0xf
    v_lshlrev_b32 v14, 16, v7
    v_and_b32 v15, 0xffff0000, v7
    v_add_f32_dpp v16, v16, v16 row_ror:2 row_mask:0xf bank_mask:0xf
    s_nop 1
    v_add_f32_dpp v16, v16, v16 row_ror:4 row_mask:0xf bank_mask:0xf
    s_nop 1
    v_add_f32_dpp v16, v16, v16 row_ror:8 row_mask:0xf bank_mask:0xf
    v_mov_b32 v17, v16
    s_nop 1
    v_permlane16_swap_b32 v16, v17
    v_add_f32 v16, v16, v17
    v_mov_b32 v17, v16
    s_nop 1
    v_permlane32_swap_b32 v16, v17
    v_mul_f32 v16, 0x3b000000, v16
    v_mul_f32 v17, 0x3b000000, v17
    v_fma_f32 v17, -v16, v16, v17
    v_cvt_pk_bf16_f32 v18, v16, v17
    v_lshlrev_b32 v16, 16, v18
    v_and_b32 v17, 0xffff0000, v18
    v_add_f32 v17, 0x3727c5ac, v17
    v_cvt_pk_bf16_f32 v17, v17, v17
    v_and_b32 v17, 0xffff0000, v17
    v_sqrt_f32 v17, v17
    v_sub_f32 v28, v8, v16
    v_sub_f32 v29, v9, v16
    v_sub_f32 v30, v10, v16
    v_sub_f32 v31, v11, v16
    v_sub_f32 v32, v12, v16
    v_sub_f32 v33, v13, v16
    v_sub_f32 v34, v14, v16
    v_sub_f32 v35, v15, v16
    v_cvt_pk_bf16_f32 v17, v17, v17
    v_and_b32 v17, 0xffff0000, v17
    v_rcp_f32 v17, v17
    v_cvt_pk_bf16_f32 v4, v28, v29
    v_cvt_pk_bf16_f32 v5, v30, v31
    v_cvt_pk_bf16_f32 v6, v32, v33
    v_cvt_pk_bf16_f32 v7, v34, v35
    v_lshlrev_b32 v8, 16, v4
    v_and_b32 v9, 0xffff0000, v4
    v_lshlrev_b32 v10, 16, v5
    v_and_b32 v11, 0xffff0000, v5
    v_lshlrev_b32 v12, 16, v6
    v_and_b32 v13, 0xffff0000, v6
    v_lshlrev_b32 v14, 16, v7
    v_and_b32 v15, 0xffff0000, v7
    v_mul_f32 v8, v8, v17
    v_mul_f32 v9, v9, v17
    v_mul_f32 v10, v10, v17
    v_mul_f32 v11, v11, v17
    v_mul_f32 v12, v12, v17
    v_mul_f32 v13, v13, v17
    v_mul_f32 v14, v14, v17
    v_mul_f32 v15, v15, v17
    v_cvt_pk_bf16_f32 v8, v8, v8
    ds_write_b32 v63, v8 offset:6272
    v_cvt_pk_bf16_f32 v9, v9, v9
    ds_write_b32 v63, v9 offset:6544
    v_cvt_pk_bf16_f32 v10, v10, v10
    ds_write_b32 v63, v10 offset:6816
    v_cvt_pk_bf16_f32 v11, v11, v11
    ds_write_b32 v63, v11 offset:7088
    v_cvt_pk_bf16_f32 v12, v12, v12
    ds_write_b32 v63, v12 offset:7360
    v_cvt_pk_bf16_f32 v13, v13, v13
    ds_write_b32 v63, v13 offset:7632
    v_cvt_pk_bf16_f32 v14, v14, v14
    ds_write_b32 v63, v14 offset:7904
    v_cvt_pk_bf16_f32 v15, v15, v15
    ds_write_b32 v63, v15 offset:8176
    s_waitcnt lgkmcnt(0)
    s_or_b32 s32, s32, 0x1807
    s_add_u32 s32, s32, 1
    s_and_b32 s32, s32, 0xfe7f8
    s_or_b32 s32, s32, s38
    v_mov_b32 v57, s32
    ds_read_b128 v[28:31], v61 offset:0
    ds_read_b128 v[32:35], v61 offset:16
    ds_read_b128 v[36:39], v61 offset:32
    ds_read_b128 v[40:43], v61 offset:48
    ds_write_b32 v63, v57 offset:256
    s_lshr_b32 s61, s32, 10
    s_and_b32 s38, s32, 0xfff
    s_and_b32 s61, s61, 0x7f8
    s_xor_b32 s61, s61, s38
    s_waitcnt lgkmcnt(0)
    v_and_b32 v64, v28, v24
    v_and_b32 v65, v28, v25
    v_and_b32 v66, v28, v26
    v_and_b32 v67, v28, v27
    v_and_b32 v68, v29, v24
    v_and_b32 v69, v29, v25
    v_and_b32 v70, v29, v26
    v_and_b32 v71, v29, v27
    v_and_b32 v72, v30, v24
    v_and_b32 v73, v30, v25
    v_and_b32 v74, v30, v26
    v_and_b32 v75, v30, v27
    v_and_b32 v76, v31, v24
    v_and_b32 v77, v31, v25
    v_and_b32 v78, v31, v26
    v_and_b32 v79, v31, v27
    v_and_b32 v80, v32, v24
    v_and_b32 v81, v32, v25
    v_and_b32 v82, v32, v26
    v_and_b32 v83, v32, v27
    v_and_b32 v84, v33, v24
    v_and_b32 v85, v33, v25
    v_and_b32 v86, v33, v26
    v_and_b32 v87, v33, v27
    v_and_b32 v88, v34, v24
    v_and_b32 v89, v34, v25
    v_and_b32 v90, v34, v26
    v_and_b32 v91, v34, v27
    v_and_b32 v92, v35, v24
    v_and_b32 v93, v35, v25
    v_and_b32 v94, v35, v26
    v_and_b32 v95, v35, v27
    v_and_b32 v96, v36, v24
    v_and_b32 v97, v36, v25
    v_and_b32 v98, v36, v26
    v_and_b32 v99, v36, v27
    v_and_b32 v100, v37, v24
    v_and_b32 v101, v37, v25
    v_and_b32 v102, v37, v26
    v_and_b32 v103, v37, v27
    v_and_b32 v104, v38, v24
    v_and_b32 v105, v38, v25
    v_and_b32 v106, v38, v26
    v_and_b32 v107, v38, v27
    v_and_b32 v108, v39, v24
    v_and_b32 v109, v39, v25
    v_and_b32 v110, v39, v26
    v_and_b32 v111, v39, v27
    v_and_b32 v112, v40, v24
    v_and_b32 v113, v40, v25
    v_and_b32 v114, v40, v26
    v_and_b32 v115, v40, v27
    v_and_b32 v116, v41, v24
    v_and_b32 v117, v41, v25
    v_and_b32 v118, v41, v26
    v_and_b32 v119, v41, v27
    v_and_b32 v120, v42, v24
    v_and_b32 v121, v42, v25
    v_and_b32 v122, v42, v26
    v_and_b32 v123, v42, v27
    v_and_b32 v124, v43, v24
    v_and_b32 v125, v43, v25
    v_and_b32 v126, v43, v26
    v_and_b32 v127, v43, v27
    s_movk_i32 s45, 64
    s_add_u32 s45, s45, 4
    s_mov_b32 s39, 160000
L_qw0_w:
    ds_read_b32 v16, v63 offset:0
    ds_read_b128 v[28:31], v60 offset:10752
    ds_read_b128 v[32:35], v60 offset:11776
    ds_read_b128 v[36:39], v60 offset:12800
    ds_read_b128 v[40:43], v60 offset:13824
    s_sub_u32 s39, s39, 1
    s_cbranch_scc1 L_qw0_ok
    s_waitcnt lgkmcnt(0)
    v_cmp_gt_u32 vcc, s45, v16
    s_nop 0
    s_cbranch_vccnz L_qw0_w
L_qw0_ok:
    s_waitcnt lgkmcnt(0)
    v_mfma_f32_16x16x32_bf16 v[52:55], v[64:67], v[28:31], 0
    v_mfma_f32_16x16x32_bf16 v[48:51], v[68:71], v[32:35], 0
    v_mfma_f32_16x16x32_bf16 v[52:55], v[72:75], v[36:39], v[52:55]
    v_mfma_f32_16x16x32_bf16 v[48:51], v[76:79], v[40:43], v[48:51]
    s_add_u32 s45, s45, 4
    s_mov_b32 s39, 160000
L_qw1_w:
    ds_read_b32 v16, v63 offset:0
    ds_read_b128 v[28:31], v60 offset:14848
    ds_read_b128 v[32:35], v60 offset:15872
    ds_read_b128 v[36:39], v60 offset:16896
    ds_read_b128 v[40:43], v60 offset:17920
    s_sub_u32 s39, s39, 1
    s_cbranch_scc1 L_qw1_ok
    s_waitcnt lgkmcnt(0)
    v_cmp_gt_u32 vcc, s45, v16
    s_nop 0
    s_cbranch_vccnz L_qw1_w
L_qw1_ok:
    s_waitcnt lgkmcnt(0)
    v_mfma_f32_16x16x32_bf16 v[52:55], v[80:83], v[28:31], v[52:55]
    v_mfma_f32_16x16x32_bf16 v[48:51], v[84:87], v[32:35], v[48:51]
    v_mfma_f32_16x16x32_bf16 v[52:55], v[88:91], v[36:39], v[52:55]
    v_mfma_f32_16x16x32_bf16 v[48:51], v[92:95], v[40:43], v[48:51]
    s_add_u32 s45, s45, 4
    s_mov_b32 s39, 160000
L_qw2_w:
    ds_read_b32 v16, v63 offset:0
    ds_read_b128 v[28:31], v60 offset:18944
    ds_read_b128 v[32:35], v60 offset:19968
    ds_read_b128 v[36:39], v60 offset:20992
    ds_read_b128 v[40:43], v60 offset:22016
    s_sub_u32 s39, s39, 1
    s_cbranch_scc1 L_qw2_ok
    s_waitcnt lgkmcnt(0)
    v_cmp_gt_u32 vcc, s45, v16
    s_nop 0
    s_cbranch_vccnz L_qw2_w
L_qw2_ok:
    s_waitcnt lgkmcnt(0)
    v_mfma_f32_16x16x32_bf16 v[52:55], v[96:99], v[28:31], v[52:55]
    v_mfma_f32_16x16x32_bf16 v[48:51], v[100:103], v[32:35], v[48:51]
    v_mfma_f32_16x16x32_bf16 v[52:55], v[104:107], v[36:39], v[52:55]
    v_mfma_f32_16x16x32_bf16 v[48:51], v[108:111], v[40:43], v[48:51]
    s_add_u32 s45, s45, 4
    s_mov_b32 s39, 160000
L_qw3_w:
    ds_read_b32 v16, v63 offset:0
    ds_read_b128 v[28:31], v60 offset:23040
    ds_read_b128 v[32:35], v60 offset:24064
    ds_read_b128 v[36:39], v60 offset:25088
    ds_read_b128 v[40:43], v60 offset:26112
    s_sub_u32 s39, s39, 1
    s_cbranch_scc1 L_qw3_ok
    s_waitcnt lgkmcnt(0)
    v_cmp_gt_u32 vcc, s45, v16
    s_nop 0
    s_cbranch_vccnz L_qw3_w
L_qw3_ok:
    s_waitcnt lgkmcnt(0)
    v_mfma_f32_16x16x32_bf16 v[52:55], v[112:115], v[28:31], v[52:55]
    v_mfma_f32_16x16x32_bf16 v[48:51], v[116:119], v[32:35], v[48:51]
    v_mfma_f32_16x16x32_bf16 v[52:55], v[120:123], v[36:39], v[52:55]
    v_mfma_f32_16x16x32_bf16 v[48:51], v[124:127], v[40:43], v[48:51]
    s_nop 7
    v_add_f32 v52, v52, v48
    v_add_f32 v53, v53, v49
    v_add_f32 v54, v54, v50
    v_add_f32 v55, v55, v51
    v_add_f32_dpp v48, v53, v52 row_ror:8 row_mask:0xf bank_mask:0xf
    s_nop 0
    v_add_f32_dpp v49, v55, v54 row_ror:8 row_mask:0xf bank_mask:0xf
    v_add_f32_dpp v50, v53, v52 row_ror:8 row_mask:0xf bank_mask:0xf
    v_add_f32_dpp v51, v55, v54 row_ror:8 row_mask:0xf bank_mask:0xf
    s_nop 0
    v_permlane16_swap_b32 v48, v50
    v_permlane16_swap_b32 v49, v51
    v_add_u32 v48, 0x800, v48
    v_add_u32 v49, 0x800, v49
    v_add_u32 v50, 0x800, v50
    v_add_u32 v51, 0x800, v51
    v_and_or_b32 v48, v48, v62, s38
    v_and_or_b32 v49, v49, v62, s38
    v_and_or_b32 v50, v50, v62, s61
    v_and_or_b32 v51, v51, v62, s61
    s_mov_b32 exec_lo, 0xff
    s_mov_b32 exec_hi, 0xff
    s_waitcnt vmcnt(3)
    global_store_dwordx4 v58, v[48:51], s[48:49]
    v_mov_b32 v52, v58
    s_mov_b64 exec, -1
    ds_write_b32 v63, v57 offset:512
    s_mov_b32 s44, 0
    s_waitcnt vmcnt(1)
    s_branch L_pv
L_w3:
    v_lshl_add_u32 v50, v0, 7, s37
    s_lshl_b32 s40, s3, 10
    s_lshl_b32 s41, s7, 7
    s_add_u32 s40, s40, s41
    s_add_u32 s40, s40, 888832
    v_writelane_b32 v50, s40, 26
    v_mov_b32 v52, v50
    s_barrier
    s_mov_b64 exec, 0x0
    s_mov_b64 exec, -1
    s_mov_b32 s44, 1
    s_setprio 2
L_pv:
    v_lshrrev_b32 v2, 4, v0
    v_bfe_u32 v1, v0, 2, 2
    v_and_b32 v3, 3, v0
    s_lshl_b32 s40, s44, 1
    v_xor_b32 v5, s40, v1
    v_lshlrev_b32 v5, 6, v5
    v_lshl_add_u32 v5, v1, 8, v5
    v_lshl_add_u32 v5, v2, 11, v5
    v_lshl_add_u32 v5, v3, 4, v5
    v_add_u32 v61, 76800, v5
    v_xor_b32 v60, 64, v61
    v_mul_u32_u24 v5, 320, v1
    v_lshl_add_u32 v5, v2, 4, v5
    v_lshl_add_u32 v56, v3, 6, v5
    v_lshlrev_b32 v59, 4, v2
    v_and_b32 v5, 15, v0
    v_lshlrev_b32 v5, 3, v5
    v_lshl_add_u32 v5, v2, 8, v5
    s_lshl_b32 s41, s44, 7
    s_add_u32 s40, s37, s41
    v_add_u32 v58, s40, v5
    v_mov_b32 v57, 1
    s_mov_b32 s47, 0x3fb8aa3b
    s_mov_b32 s50, 0x11111111
    s_mov_b32 s51, 0x11111111
    v_mov_b32 v32, 0
    v_mov_b32 v33, 0
    v_mov_b32 v34, 0
    v_mov_b32 v35, 0
    v_mov_b32 v36, 0
    v_mov_b32 v37, 0
    v_mov_b32 v38, 0
    v_mov_b32 v39, 0
    v_mov_b32 v40, 0
    v_mov_b32 v41, 0
    v_mov_b32 v42, 0
    v_mov_b32 v43, 0
    v_mov_b32 v44, 0
    v_mov_b32 v45, 0
    v_mov_b32 v46, 0
    v_mov_b32 v47, 0
    s_mul_i32 s45, s34, 16
    s_add_u32 s45, s45, 120
    s_mov_b32 s39, 160000
L_pv0_w:
    ds_read_b32 v18, v63 offset:0
    s_sub_u32 s39, s39, 1
    s_cbranch_scc1 L_pv0_ok
    s_waitcnt lgkmcnt(0)
    v_cmp_gt_u32 vcc, s45, v18
    s_nop 0
    s_cbranch_vccz L_pv0_ok
    s_sleep 2
    s_branch L_pv0_w
L_pv0_ok:
    s_waitcnt lgkmcnt(0)
    ds_read_b64_tr_b16 v[64:65], v61 offset:0
    ds_read_b64_tr_b16 v[66:67], v61 offset:1024
    ds_read_b64_tr_b16 v[68:69], v61 offset:8
    ds_read_b64_tr_b16 v[70:71], v61 offset:1032
    ds_read_b64_tr_b16 v[72:73], v60 offset:0
    ds_read_b64_tr_b16 v[74:75], v60 offset:1024
    ds_read_b64_tr_b16 v[76:77], v60 offset:8
    ds_read_b64_tr_b16 v[78:79], v60 offset:1032
    s_mov_b32 s39, 40
L_pw0_w:
    ds_read_b32 v4, v63 offset:1280
    s_sub_u32 s39, s39, 1
    s_cbranch_scc1 L_pw0_ok
    s_waitcnt lgkmcnt(0)
    v_cmp_gt_u32 vcc, 4, v4
    s_nop 0
    s_cbranch_vccz L_pw0_ok
    s_sleep 1
    s_branch L_pw0_w
L_pw0_ok:
    s_waitcnt lgkmcnt(0)
    v_cmp_gt_u32 vcc, 4, v4
    s_nop 0
    s_cbranch_vccz L_pw_go
    s_cmp_eq_u32 s44, 0
    s_cbranch_scc0 L_pw_nq
    s_mov_b32 exec_lo, 0xff
    s_mov_b32 exec_hi, 0xff
    global_store_dwordx4 v52, v[48:51], s[30:31] sc1
    s_mov_b64 exec, -1
L_pw_nq:
    s_mov_b32 s39, 160000
L_pw_w:
    ds_read_b32 v4, v63 offset:1280
    s_sub_u32 s39, s39, 1
    s_cbranch_scc1 L_pw_ok
    s_waitcnt lgkmcnt(0)
    v_cmp_gt_u32 vcc, 4, v4
    s_nop 0
    s_cbranch_vccz L_pw_ok
    s_sleep 1
    s_branch L_pw_w
L_pw_ok:
    s_waitcnt lgkmcnt(0)
L_pw_go:
    s_add_u32 s45, s45, 8
    s_lshl_b64 exec, s[50:51], 0
    ds_read_b128 v[32:35], v56 offset:8448
    s_lshl_b64 exec, s[50:51], 1
    ds_read_b128 v[36:39], v56 offset:8448
    s_lshl_b64 exec, s[50:51], 2
    ds_read_b128 v[40:43], v56 offset:8448
    s_lshl_b64 exec, s[50:51], 3
    ds_read_b128 v[44:47], v56 offset:8448
    s_mov_b64 exec, -1
    ds_read_b32 v5, v63 offset:256
    ds_read_b128 v[24:27], v59 offset:2048
    ds_read_b32 v7, v63 offset:0
    ds_read_b64_tr_b16 v[80:81], v61 offset:8192
    ds_read_b64_tr_b16 v[82:83], v61 offset:9216
    ds_read_b64_tr_b16 v[84:85], v61 offset:8200
    ds_read_b64_tr_b16 v[86:87], v61 offset:9224
    ds_read_b64_tr_b16 v[88:89], v60 offset:8192
    ds_read_b64_tr_b16 v[90:91], v60 offset:9216
    ds_read_b64_tr_b16 v[92:93], v60 offset:8200
    ds_read_b64_tr_b16 v[94:95], v60 offset:9224
    s_waitcnt lgkmcnt(9)
    v_mfma_f32_16x16x32_bf16 v[8:11], v[32:35], v[64:67], 0
    v_mfma_f32_16x16x32_bf16 v[12:15], v[32:35], v[68:71], 0
    v_mfma_f32_16x16x32_bf16 v[16:19], v[32:35], v[72:75], 0
    v_mfma_f32_16x16x32_bf16 v[20:23], v[32:35], v[76:79], 0
    v_readfirstlane_b32 s32, v5
    s_nop 0
    s_and_b32 s33, s32, 0xff8
    s_lshr_b32 s58, s32, 10
    s_and_b32 s58, s58, 0x7f8
    s_xor_b32 s58, s58, s33
    v_max3_f32 v6, v24, v25, v26
    v_max_f32 v6, v6, v27
    v_sub_f32 v24, v24, v6
    v_sub_f32 v25, v25, v6
    v_sub_f32 v26, v26, v6
    v_sub_f32 v27, v27, v6
    v_mul_f32 v24, s47, v24
    v_mul_f32 v25, s47, v25
    v_mul_f32 v26, s47, v26
    v_mul_f32 v27, s47, v27
    v_exp_f32 v24, v24
    v_exp_f32 v25, v25
    v_exp_f32 v26, v26
    v_exp_f32 v27, v27
    s_waitcnt lgkmcnt(0)
    v_cmp_gt_u32 vcc, s45, v7
    s_nop 0
    s_cbranch_vccz L_pv1_ok
    s_mov_b32 s39, 160000
L_pv1_w:
    ds_read_b32 v7, v63 offset:0
    ds_read_b64_tr_b16 v[80:81], v61 offset:8192
    ds_read_b64_tr_b16 v[82:83], v61 offset:9216
    ds_read_b64_tr_b16 v[84:85], v61 offset:8200
    ds_read_b64_tr_b16 v[86:87], v61 offset:9224
    ds_read_b64_tr_b16 v[88:89], v60 offset:8192
    ds_read_b64_tr_b16 v[90:91], v60 offset:9216
    ds_read_b64_tr_b16 v[92:93], v60 offset:8200
    ds_read_b64_tr_b16 v[94:95], v60 offset:9224
    s_sub_u32 s39, s39, 1
    s_cbranch_scc1 L_pv1_ok
    s_waitcnt lgkmcnt(0)
    v_cmp_gt_u32 vcc, s45, v7
    s_nop 0
    s_cbranch_vccz L_pv1_ok
    s_sleep 1
    s_branch L_pv1_w
L_pv1_ok:
    s_waitcnt lgkmcnt(0)
    s_add_u32 s45, s45, 8
    ds_read_b32 v7, v63 offset:0
    ds_read_b64_tr_b16 v[96:97], v61 offset:16384
    ds_read_b64_tr_b16 v[98:99], v61 offset:17408
    ds_read_b64_tr_b16 v[100:101], v61 offset:16392
    ds_read_b64_tr_b16 v[102:103], v61 offset:17416
    ds_read_b64_tr_b16 v[104:105], v60 offset:16384
    ds_read_b64_tr_b16 v[106:107], v60 offset:17408
    ds_read_b64_tr_b16 v[108:109], v60 offset:16392
    ds_read_b64_tr_b16 v[110:111], v60 offset:17416
    v_mfma_f32_16x16x32_bf16 v[8:11], v[36:39], v[80:83], v[8:11]
    v_mfma_f32_16x16x32_bf16 v[12:15], v[36:39], v[84:87], v[12:15]
    v_mfma_f32_16x16x32_bf16 v[16:19], v[36:39], v[88:91], v[16:19]
    v_mfma_f32_16x16x32_bf16 v[20:23], v[36:39], v[92:95], v[20:23]
    s_waitcnt lgkmcnt(0)
    v_cmp_gt_u32 vcc, s45, v7
    s_nop 0
    s_cbranch_vccz L_pv2_ok
    s_mov_b32 s39, 160000
L_pv2_w:
    ds_read_b32 v7, v63 offset:0
    ds_read_b64_tr_b16 v[96:97], v61 offset:16384
    ds_read_b64_tr_b16 v[98:99], v61 offset:17408
    ds_read_b64_tr_b16 v[100:101], v61 offset:16392
    ds_read_b64_tr_b16 v[102:103], v61 offset:17416
    ds_read_b64_tr_b16 v[104:105], v60 offset:16384
    ds_read_b64_tr_b16 v[106:107], v60 offset:17408
    ds_read_b64_tr_b16 v[108:109], v60 offset:16392
    ds_read_b64_tr_b16 v[110:111], v60 offset:17416
    s_sub_u32 s39, s39, 1
    s_cbranch_scc1 L_pv2_ok
    s_waitcnt lgkmcnt(0)
    v_cmp_gt_u32 vcc, s45, v7
    s_nop 0
    s_cbranch_vccz L_pv2_ok
    s_sleep 1
    s_branch L_pv2_w
L_pv2_ok:
    s_waitcnt lgkmcnt(0)
    s_add_u32 s45, s45, 8
    ds_read_b32 v7, v63 offset:0
    ds_read_b64_tr_b16 v[112:113], v61 offset:24576
    ds_read_b64_tr_b16 v[114:115], v61 offset:25600
    ds_read_b64_tr_b16 v[116:117], v61 offset:24584
    ds_read_b64_tr_b16 v[118:119], v61 offset:25608
    ds_read_b64_tr_b16 v[120:121], v60 offset:24576
    ds_read_b64_tr_b16 v[122:123], v60 offset:25600
    ds_read_b64_tr_b16 v[124:125], v60 offset:24584
    ds_read_b64_tr_b16 v[126:127], v60 offset:25608
    v_mfma_f32_16x16x32_bf16 v[8:11], v[40:43], v[96:99], v[8:11]
    v_mfma_f32_16x16x32_bf16 v[12:15], v[40:43], v[100:103], v[12:15]
    v_mfma_f32_16x16x32_bf16 v[16:19], v[40:43], v[104:107], v[16:19]
    v_mfma_f32_16x16x32_bf16 v[20:23], v[40:43], v[108:111], v[20:23]
    s_waitcnt lgkmcnt(0)
    v_cmp_gt_u32 vcc, s45, v7
    s_nop 0
    s_cbranch_vccz L_pv_rdy
    s_nop 0
    v_mul_f32 v28, v8, v24
    v_mul_f32 v29, v12, v24
    v_mul_f32 v30, v16, v24
    v_mul_f32 v31, v20, v24
    v_fmac_f32 v28, v9, v25
    v_fmac_f32 v29, v13, v25
    v_fmac_f32 v30, v17, v25
    v_fmac_f32 v31, v21, v25
    v_fmac_f32 v28, v10, v26
    v_fmac_f32 v29, v14, v26
    v_fmac_f32 v30, v18, v26
    v_fmac_f32 v31, v22, v26
    s_mov_b32 s39, 160000
L_pv3_w:
    ds_read_b32 v7, v63 offset:0
    ds_read_b64_tr_b16 v[112:113], v61 offset:24576
    ds_read_b64_tr_b16 v[114:115], v61 offset:25600
    ds_read_b64_tr_b16 v[116:117], v61 offset:24584
    ds_read_b64_tr_b16 v[118:119], v61 offset:25608
    ds_read_b64_tr_b16 v[120:121], v60 offset:24576
    ds_read_b64_tr_b16 v[122:123], v60 offset:25600
    ds_read_b64_tr_b16 v[124:125], v60 offset:24584
    ds_read_b64_tr_b16 v[126:127], v60 offset:25608
    s_sub_u32 s39, s39, 1
    s_cbranch_scc1 L_pv3_ok
    s_waitcnt lgkmcnt(0)
    v_cmp_gt_u32 vcc, s45, v7
    s_nop 0
    s_cbranch_vccnz L_pv3_w
L_pv3_ok:
    s_waitcnt lgkmcnt(0)
    v_mfma_f32_16x16x32_bf16 v[64:67], v[44:47], v[112:115], 0
    v_mfma_f32_16x16x32_bf16 v[68:71], v[44:47], v[116:119], 0
    v_mfma_f32_16x16x32_bf16 v[72:75], v[44:47], v[120:123], 0
    v_mfma_f32_16x16x32_bf16 v[76:79], v[44:47], v[124:127], 0
    s_branch L_pv_end
L_pv_rdy:
    v_mfma_f32_16x16x32_bf16 v[64:67], v[44:47], v[112:115], 0
    v_mfma_f32_16x16x32_bf16 v[68:71], v[44:47], v[116:119], 0
    v_mfma_f32_16x16x32_bf16 v[72:75], v[44:47], v[120:123], 0
    v_mfma_f32_16x16x32_bf16 v[76:79], v[44:47], v[124:127], 0
    v_mul_f32 v28, v8, v24
    v_mul_f32 v29, v12, v24
    v_mul_f32 v30, v16, v24
    v_mul_f32 v31, v20, v24
    v_fmac_f32 v28, v9, v25
    v_fmac_f32 v29, v13, v25
    v_fmac_f32 v30, v17, v25
    v_fmac_f32 v31, v21, v25
    v_fmac_f32 v28, v10, v26
    v_fmac_f32 v29, v14, v26
    v_fmac_f32 v30, v18, v26
    v_fmac_f32 v31, v22, v26
L_pv_end:
    s_nop 7
    v_fmac_f32 v28, v67, v27
    v_fmac_f32 v29, v71, v27
    v_fmac_f32 v30, v75, v27
    v_fmac_f32 v31, v79, v27
    v_cvt_pk_f16_f32 v24, v28, v29
    v_cvt_pk_f16_f32 v25, v30, v31
    global_store_dwordx2 v58, v[24:25], s[48:49]
    ds_add_u32 v63, v57 offset:1536
    s_bitcmp1_b32 s32, 12
    s_cbranch_scc0 L_finish
    s_sub_u32 s40, 0x800, s33
    s_sub_u32 s41, 0x800, s58
    v_lshlrev_b32 v58, 1, v58
    v_subrev_u32 v58, s37, v58
    v_add_u32 v28, s40, v28
    v_add_u32 v29, s40, v29
    v_add_u32 v30, s41, v30
    v_add_u32 v31, s41, v31
    v_and_or_b32 v28, v28, v62, s33
    v_and_or_b32 v29, v29, v62, s33
    v_and_or_b32 v30, v30, v62, s58
    v_and_or_b32 v31, v31, v62, s58
    global_store_dwordx4 v58, v[28:31], s[30:31] sc1
    s_cmp_eq_u32 s44, 0
    s_cbranch_scc0 L_pe_nq
    s_mov_b32 exec_lo, 0xff
    s_mov_b32 exec_hi, 0xff
    global_store_dwordx4 v52, v[48:51], s[30:31] sc1
    s_mov_b64 exec, -1
L_pe_nq:
    s_branch L_finish
L_ffn:
    v_mov_b32 v21, 0
    ds_write_b32 v21, v21 offset:2176
    s_lshl_b32 s40, s7, 7
    v_lshl_add_u32 v1, v0, 1, s40
    s_add_u32 s40, s40, 901120
    v_mov_b32 v22, s40
    s_waitcnt lgkmcnt(0)
    s_barrier
    s_setprio 1
    global_load_ushort v23, v1, s[8:9]
    v_lshrrev_b32 v1, 3, v0
    s_lshl_b32 s40, s7, 3
    v_add_u32 v1, s40, v1
    v_lshlrev_b32 v1, 8, v1
    v_and_b32 v54, 7, v0
    v_lshl_add_u32 v1, v54, 3, v1
    v_add_u32 v54, 950400, v1
    v_bfe_u32 v16, v0, 1, 1
    v_lshlrev_b32 v16, 4, v16
    v_mov_b32 v17, 0xffff
    v_lshlrev_b32 v16, v16, v17
    v_bfe_u32 v17, v0, 2, 2
    v_cmp_eq_u32 vcc, 0, v17
    s_nop 1
    v_cndmask_b32 v24, 0, v16, vcc
    v_cmp_eq_u32 vcc, 1, v17
    s_nop 1
    v_cndmask_b32 v25, 0, v16, vcc
    v_cmp_eq_u32 vcc, 2, v17
    s_nop 1
    v_cndmask_b32 v26, 0, v16, vcc
    v_cmp_eq_u32 vcc, 3, v17
    s_nop 1
    v_cndmask_b32 v27, 0, v16, vcc
    v_lshrrev_b32 v3, 4, v0
    v_and_b32 v16, 1, v0
    v_lshl_add_u32 v3, v3, 1, v16
    s_lshl_b32 s40, s7, 5
    s_add_u32 s40, s40, 6272
    v_mul_u32_u24 v61, 272, v3
    v_add_u32 v61, s40, v61
    v_lshlrev_b32 v59, 5, v3
    s_cmp_eq_u32 s34, 0
    s_cbranch_scc1 L_fin
    v_lshrrev_b32 v1, 4, v0
    v_and_b32 v2, 7, v0
    v_lshlrev_b32 v4, 4, v2
    v_lshl_add_u32 v4, v1, 7, v4
    s_add_u32 s40, s37, 2048
    v_add_u32 v58, s40, v4
    s_mul_i32 s40, s6, 27648
    s_add_u32 s40, s40, s36
    s_add_u32 s40, s40, 1050624
    v_lshrrev_b32 v5, 5, v0
    v_mul_u32_u24 v4, 13824, v5
    v_and_b32 v6, 31, v0
    v_lshl_add_u32 v4, v6, 4, v4
    v_add_u32 v57, s40, v4
    v_add_u32 v52, 6912, v57
    v_bfe_u32 v4, v0, 3, 2
    v_lshl_add_u32 v4, v4, 1, v5
    v_lshlrev_b32 v4, 5, v4
    v_lshl_add_u32 v56, v2, 2, v4
    v_and_b32 v4, 15, v0
    v_lshlrev_b32 v4, 5, v4
    v_lshl_add_u32 v55, v1, 3, v4
    v_add_u32 v53, 109568, v60
    v_mov_b32 v48, 0x800
    v_mov_b32 v49, 0x800
    v_mov_b32 v50, 0x800
    v_mov_b32 v51, 0x800
    s_mov_b32 exec_lo, 0xff00ff
    s_mov_b32 exec_hi, 0xff00ff
    global_store_dwordx4 v58, v[48:51], s[48:49]
    s_mov_b32 exec_lo, 0x10001
    s_mov_b32 exec_hi, 0x10001
    global_load_dword v17, v58, s[48:49] nt
    s_mov_b64 exec, -1
    s_mov_b32 s39, 160000
L_fx_w:
    ds_read_b32 v16, v63 offset:256
    ds_read_b128 v[28:31], v61 offset:0
    ds_read_b128 v[32:35], v61 offset:16
    s_sub_u32 s39, s39, 1
    s_cbranch_scc1 L_fx_ok
    s_waitcnt lgkmcnt(0)
    v_cmp_gt_u32 vcc, 1, v16
    s_nop 0
    s_cbranch_vccz L_fx_ok
    s_sleep 2
    s_branch L_fx_w
L_fx_ok:
    s_waitcnt lgkmcnt(0)
    v_readfirstlane_b32 s32, v16
    s_movk_i32 s57, 0xfff
    s_and_b32 s33, s32, 0xff8
    s_lshr_b32 s58, s32, 10
    s_and_b32 s38, s32, s57
    s_and_b32 s58, s58, 0x7f8
    s_xor_b32 s61, s58, s38
    s_xor_b32 s58, s58, s33
    s_movk_i32 s40, 96
    s_waitcnt vmcnt(0)
    s_mov_b32 s39, 160000
L_fg_w:
    ds_read_b32 v16, v63 offset:0
    s_sub_u32 s39, s39, 1
    s_cbranch_scc1 L_fg_ok
    s_waitcnt lgkmcnt(0)
    v_cmp_gt_u32 vcc, s40, v16
    s_nop 0
    s_cbranch_vccz L_fg_ok
    s_sleep 1
    s_branch L_fg_w
L_fg_ok:
    s_waitcnt lgkmcnt(0)
    ds_read_b128 v[64:67], v60 offset:27136
    ds_read_b128 v[68:71], v60 offset:35328
    ds_read_b128 v[72:75], v60 offset:28160
    ds_read_b128 v[76:79], v60 offset:36352
    ds_read_b128 v[80:83], v60 offset:29184
    ds_read_b128 v[84:87], v60 offset:37376
    ds_read_b128 v[88:91], v60 offset:30208
    ds_read_b128 v[92:95], v60 offset:38400
    ds_read_b128 v[96:99], v60 offset:31232
    ds_read_b128 v[100:103], v60 offset:39424
    ds_read_b128 v[104:107], v60 offset:32256
    ds_read_b128 v[108:111], v60 offset:40448
    ds_read_b128 v[112:115], v60 offset:33280
    ds_read_b128 v[116:119], v60 offset:41472
    ds_read_b128 v[120:123], v60 offset:34304
    ds_read_b128 v[124:127], v60 offset:42496
    v_and_b32 v44, v28, v24
    v_and_b32 v45, v28, v25
    v_and_b32 v46, v28, v26
    v_and_b32 v47, v28, v27
    v_and_b32 v48, v29, v24
    v_and_b32 v49, v29, v25
    v_and_b32 v50, v29, v26
    v_and_b32 v51, v29, v27
    s_waitcnt lgkmcnt(14)
    v_mfma_f32_16x16x32_bf16 v[8:11], v[44:47], v[64:67], 0
    v_mfma_f32_16x16x32_bf16 v[12:15], v[44:47], v[68:71], 0
    v_and_b32 v44, v30, v24
    v_and_b32 v45, v30, v25
    v_and_b32 v46, v30, v26
    v_and_b32 v47, v30, v27
    s_waitcnt lgkmcnt(12)
    v_mfma_f32_16x16x32_bf16 v[8:11], v[48:51], v[72:75], v[8:11]
    v_mfma_f32_16x16x32_bf16 v[12:15], v[48:51], v[76:79], v[12:15]
    v_and_b32 v48, v31, v24
    v_and_b32 v49, v31, v25
    v_and_b32 v50, v31, v26
    v_and_b32 v51, v31, v27
    s_waitcnt lgkmcnt(10)
    v_mfma_f32_16x16x32_bf16 v[8:11], v[44:47], v[80:83], v[8:11]
    v_mfma_f32_16x16x32_bf16 v[12:15], v[44:47], v[84:87], v[12:15]
    v_and_b32 v44, v32, v24
    v_and_b32 v45, v32, v25
    v_and_b32 v46, v32, v26
    v_and_b32 v47, v32, v27
    s_waitcnt lgkmcnt(8)
    v_mfma_f32_16x16x32_bf16 v[8:11], v[48:51], v[88:91], v[8:11]
    v_mfma_f32_16x16x32_bf16 v[12:15], v[48:51], v[92:95], v[12:15]
    v_and_b32 v48, v33, v24
    v_and_b32 v49, v33, v25
    v_and_b32 v50, v33, v26
    v_and_b32 v51, v33, v27
    s_waitcnt lgkmcnt(6)
    v_mfma_f32_16x16x32_bf16 v[8:11], v[44:47], v[96:99], v[8:11]
    v_mfma_f32_16x16x32_bf16 v[12:15], v[44:47], v[100:103], v[12:15]
    v_and_b32 v44, v34, v24
    v_and_b32 v45, v34, v25
    v_and_b32 v46, v34, v26
    v_and_b32 v47, v34, v27
    s_waitcnt lgkmcnt(4)
    v_mfma_f32_16x16x32_bf16 v[8:11], v[48:51], v[104:107], v[8:11]
    v_mfma_f32_16x16x32_bf16 v[12:15], v[48:51], v[108:111], v[12:15]
    v_and_b32 v48, v35, v24
    v_and_b32 v49, v35, v25
    v_and_b32 v50, v35, v26
    v_and_b32 v51, v35, v27
    s_waitcnt lgkmcnt(2)
    v_mfma_f32_16x16x32_bf16 v[8:11], v[44:47], v[112:115], v[8:11]
    v_mfma_f32_16x16x32_bf16 v[12:15], v[44:47], v[116:119], v[12:15]
    s_waitcnt lgkmcnt(0)
    v_mfma_f32_16x16x32_bf16 v[8:11], v[48:51], v[120:123], v[8:11]
    v_mfma_f32_16x16x32_bf16 v[12:15], v[48:51], v[124:127], v[12:15]
    s_nop 6
    v_add_f32_dpp v48, v9, v8 row_ror:8 row_mask:0xf bank_mask:0xf
    v_add_f32_dpp v49, v11, v10 row_ror:8 row_mask:0xf bank_mask:0xf
    v_add_f32_dpp v50, v13, v12 row_ror:8 row_mask:0xf bank_mask:0xf
    v_add_f32_dpp v51, v15, v14 row_ror:8 row_mask:0xf bank_mask:0xf
    v_add_u32 v48, 0x800, v48
    v_add_u32 v49, 0x800, v49
    v_add_u32 v50, 0x800, v50
    v_add_u32 v51, 0x800, v51
    v_and_or_b32 v48, v48, v62, s38
    v_and_or_b32 v49, v49, v62, s38
    v_and_or_b32 v50, v50, v62, s61
    v_and_or_b32 v51, v51, v62, s61
    s_mov_b32 exec_lo, 0xff00ff
    s_mov_b32 exec_hi, 0xff00ff
    global_store_dwordx4 v58, v[48:51], s[48:49]
    s_mov_b64 exec, -1
    s_movk_i32 s40, 136
    s_mov_b32 s39, 160000
L_fw_w:
    ds_read_b32 v16, v63 offset:0
    s_sub_u32 s39, s39, 1
    s_cbranch_scc1 L_fw_ok
    s_waitcnt lgkmcnt(0)
    v_cmp_gt_u32 vcc, s40, v16
    s_nop 0
    s_cbranch_vccz L_fw_ok
    s_sleep 1
    s_branch L_fw_w
L_fw_ok:
    s_waitcnt lgkmcnt(0)
    s_mov_b32 s39, 20000
    global_load_dwordx4 v[64:67], v57, s[30:31] sc1
    global_load_dwordx4 v[68:71], v57, s[30:31] offset:3456 sc1
    global_load_dwordx4 v[72:75], v52, s[30:31] sc1
    global_load_dwordx4 v[76:79], v52, s[30:31] offset:3456 sc1
    global_load_dwordx4 v[80:83], v22, s[30:31] sc1
L_f1_poll:
    s_waitcnt vmcnt(4)
    v_xor_b32 v28, s38, v64
    v_xor_b32 v29, s38, v65
    v_xor_b32 v30, s61, v66
    v_xor_b32 v31, s61, v67
    v_or_b32 v16, v28, v29
    v_or3_b32 v16, v16, v30, v31
    s_waitcnt vmcnt(3)
    v_xor_b32 v32, s38, v68
    v_xor_b32 v33, s38, v69
    v_xor_b32 v34, s61, v70
    v_xor_b32 v35, s61, v71
    v_or3_b32 v16, v16, v32, v33
    v_or3_b32 v16, v16, v34, v35
    s_waitcnt vmcnt(2)
    v_xor_b32 v36, s38, v72
    v_xor_b32 v37, s38, v73
    v_xor_b32 v38, s61, v74
    v_xor_b32 v39, s61, v75
    v_or3_b32 v16, v16, v36, v37
    v_or3_b32 v16, v16, v38, v39
    s_waitcnt vmcnt(1)
    v_xor_b32 v40, s38, v76
    v_xor_b32 v41, s38, v77
    v_xor_b32 v42, s61, v78
    v_xor_b32 v43, s61, v79
    v_or3_b32 v16, v16, v40, v41
    v_or3_b32 v16, v16, v42, v43
    s_waitcnt vmcnt(0)
    v_xor_b32 v44, s33, v80
    v_xor_b32 v45, s33, v81
    v_xor_b32 v46, s33, v82
    v_xor_b32 v47, s33, v83
    v_or3_b32 v16, v16, v44, v45
    v_or3_b32 v16, v16, v46, v47
    v_and_b32 v16, s57, v16
    v_cmp_ne_u32 vcc, 0, v16
    s_nop 0
    s_and_b64 exec, exec, vcc
    s_cbranch_scc0 L_f1_done
    global_load_dwordx4 v[64:67], v57, s[30:31] sc1
    global_load_dwordx4 v[68:71], v57, s[30:31] offset:3456 sc1
    global_load_dwordx4 v[72:75], v52, s[30:31] sc1
    global_load_dwordx4 v[76:79], v52, s[30:31] offset:3456 sc1
    global_load_dwordx4 v[80:83], v22, s[30:31] sc1
    s_sub_u32 s39, s39, 1
    s_cbranch_scc1 L_f1_done
    s_cmp_gt_u32 s39, 19976
    s_cbranch_scc1 L_f1_poll
    v_xor_b32 v52, 0x100000, v52
    v_xor_b32 v57, 0x100000, v57
    s_cmp_lg_u32 s39, 19976
    s_cbranch_scc1 L_f1_poll
    s_movk_i32 s57, 0xff8
    s_mov_b64 s[54:55], exec
    s_mov_b32 exec_lo, 0xff00ff
    s_mov_b32 exec_hi, 0xff00ff
    global_store_dwordx4 v58, v[48:51], s[30:31] sc1
    s_mov_b64 exec, s[54:55]
    s_branch L_f1_poll
L_f1_clean:
    v_and_b32 v28, v62, v28
    v_and_b32 v29, v62, v29
    v_and_b32 v30, v62, v30
    v_and_b32 v31, v62, v31
    v_and_b32 v32, v62, v32
    v_and_b32 v33, v62, v33
    v_and_b32 v34, v62, v34
    v_and_b32 v35, v62, v35
    v_and_b32 v36, v62, v36
    v_and_b32 v37, v62, v37
    v_and_b32 v38, v62, v38
    v_and_b32 v39, v62, v39
    v_and_b32 v40, v62, v40
    v_and_b32 v41, v62, v41
    v_and_b32 v42, v62, v42
    v_and_b32 v43, v62, v43
    s_branch L_f1_cl
L_f1_done:
    s_bitcmp0_b32 s57, 0
    s_mov_b64 exec, -1
    s_cbranch_scc1 L_f1_clean
L_f1_cl:
    v_mov_b32 v20, 1
    v_lshlrev_b32 v23, 16, v23
    ds_write_b32 v63, v23 offset:9728
    ds_write_b32 v21, v20 offset:2176
    v_add_f32 v28, v28, v32
    v_add_f32 v29, v29, v33
    v_add_f32 v30, v30, v34
    v_add_f32 v31, v31, v35
    v_add_f32 v36, v36, v40
    v_add_f32 v37, v37, v41
    v_add_f32 v38, v38, v42
    v_add_f32 v39, v39, v43
    v_add_f32 v28, v28, v36
    v_add_f32 v29, v29, v37
    v_add_f32 v30, v30, v38
    v_add_f32 v31, v31, v39
    v_permlane32_swap_b32 v28, v29
    s_nop 0
    v_permlane32_swap_b32 v30, v31
    v_add_f32 v4, v28, v29
    v_add_f32 v5, v30, v31
    v_cvt_pk_bf16_f32 v6, v4, v5
    v_lshlrev_b32 v4, 16, v6
    v_and_b32 v5, 0xffff0000, v6
    v_mov_b32 v16, 0xc0135761
    s_mov_b32 s40, 0xbdd2d3e8
    v_mul_f32 v6, v4, v4
    v_fma_f32 v6, v6, s40, v16
    v_mul_f32 v6, v6, v4
    v_exp_f32 v6, v6
    s_nop 0
    v_add_f32 v6, 1.0, v6
    v_rcp_f32 v6, v6
    s_nop 0
    v_mul_f32 v6, v6, v4
    v_cvt_pk_bf16_f32 v6, v6, v6
    v_and_b32 v6, 0xffff0000, v6
    v_mul_f32 v6, v6, v5
    v_cvt_pk_bf16_f32 v6, v6, v6
    ds_write_b32 v56, v6 offset:2304
    ds_read_b128 v[28:31], v59 offset:2304
    ds_read_b128 v[32:35], v59 offset:2320
    s_waitcnt vmcnt(0) lgkmcnt(0)
    v_and_b32 v96, v28, v24
    v_and_b32 v97, v28, v25
    v_and_b32 v98, v28, v26
    v_and_b32 v99, v28, v27
    v_and_b32 v100, v29, v24
    v_and_b32 v101, v29, v25
    v_and_b32 v102, v29, v26
    v_and_b32 v103, v29, v27
    v_and_b32 v104, v30, v24
    v_and_b32 v105, v30, v25
    v_and_b32 v106, v30, v26
    v_and_b32 v107, v30, v27
    v_and_b32 v108, v31, v24
    v_and_b32 v109, v31, v25
    v_and_b32 v110, v31, v26
    v_and_b32 v111, v31, v27
    v_and_b32 v112, v32, v24
    v_and_b32 v113, v32, v25
    v_and_b32 v114, v32, v26
    v_and_b32 v115, v32, v27
    v_and_b32 v116, v33, v24
    v_and_b32 v117, v33, v25
    v_and_b32 v118, v33, v26
    v_and_b32 v119, v33, v27
    v_and_b32 v120, v34, v24
    v_and_b32 v121, v34, v25
    v_and_b32 v122, v34, v26
    v_and_b32 v123, v34, v27
    v_and_b32 v124, v35, v24
    v_and_b32 v125, v35, v25
    v_and_b32 v126, v35, v26
    v_and_b32 v127, v35, v27
    s_movk_i32 s40, 168
    s_mov_b32 s39, 160000
L_fd_w:
    ds_read_b32 v16, v63 offset:0
    s_sub_u32 s39, s39, 1
    s_cbranch_scc1 L_fd_ok
    s_waitcnt lgkmcnt(0)
    v_cmp_gt_u32 vcc, s40, v16
    s_nop 0
    s_cbranch_vccz L_fd_ok
    s_sleep 1
    s_branch L_fd_w
L_fd_ok:
    s_waitcnt lgkmcnt(0)
    ds_read_b128 v[64:67], v53 offset:0
    ds_read_b128 v[68:71], v53 offset:1024
    ds_read_b128 v[72:75], v53 offset:2048
    ds_read_b128 v[76:79], v53 offset:3072
    ds_read_b128 v[80:83], v53 offset:4096
    ds_read_b128 v[84:87], v53 offset:5120
    ds_read_b128 v[88:91], v53 offset:6144
    ds_read_b128 v[92:95], v53 offset:7168
    s_waitcnt lgkmcnt(7)
    v_mfma_f32_16x16x32_bf16 v[8:11], v[96:99], v[64:67], 0
    s_waitcnt lgkmcnt(6)
    v_mfma_f32_16x16x32_bf16 v[8:11], v[100:103], v[68:71], v[8:11]
    s_waitcnt lgkmcnt(5)
    v_mfma_f32_16x16x32_bf16 v[8:11], v[104:107], v[72:75], v[8:11]
    s_waitcnt lgkmcnt(4)
    v_mfma_f32_16x16x32_bf16 v[8:11], v[108:111], v[76:79], v[8:11]
    s_waitcnt lgkmcnt(3)
    v_mfma_f32_16x16x32_bf16 v[8:11], v[112:115], v[80:83], v[8:11]
    s_waitcnt lgkmcnt(2)
    v_mfma_f32_16x16x32_bf16 v[8:11], v[116:119], v[84:87], v[8:11]
    s_waitcnt lgkmcnt(1)
    v_mfma_f32_16x16x32_bf16 v[8:11], v[120:123], v[88:91], v[8:11]
    s_waitcnt lgkmcnt(0)
    v_mfma_f32_16x16x32_bf16 v[8:11], v[124:127], v[92:95], v[8:11]
    s_nop 7
    v_add_f32_dpp v4, v9, v8 row_ror:8 row_mask:0xf bank_mask:0xf
    v_add_f32_dpp v5, v11, v10 row_ror:8 row_mask:0xf bank_mask:0xf
    ds_write_b64 v55, v[4:5] offset:2560
    ds_read_b32 v4, v63 offset:2560
    s_mov_b32 s52, 0
    s_mov_b32 s53, 0x41b80000
    s_waitcnt lgkmcnt(0)
    v_cvt_f64_f32 v[14:15], v4
    v_add_f64 v[14:15], v[14:15], s[52:53]
    v_lshl_or_b32 v12, v14, 22, 1
    v_alignbit_b32 v13, v15, v14, 10
    global_atomic_add_x2 v[14:15], v54, v[12:13], s[30:31] sc0 sc1
    v_add_u32 v53, 0xffff7f80, v54
    s_lshl_b32 s40, s7, 7
    v_lshl_add_u32 v54, v0, 1, s40
    v_mov_b32 v19, v23
    s_mov_b32 s56, 0
    s_waitcnt vmcnt(0)
    v_lshl_add_u64 v[12:13], v[12:13], 0, v[14:15]
    v_lshrrev_b32 v9, 22, v12
    v_cvt_f32_i32 v8, v13
    v_cvt_f32_u32 v9, v9
    v_and_b32 v10, 63, v12
    v_fmac_f32 v8, 0x3a800000, v9
    v_cmp_eq_u32 vcc, 28, v10
    v_mul_f32 v8, 0x38800000, v8
    v_cvt_pk_bf16_f32 v8, v8, v8
    v_and_b32 v8, 0xffff0000, v8
    s_mov_b64 s[42:43], vcc
    s_cbranch_vccz L_f_nog
    v_mul_f32 v9, 0xbfb8aa3b, v8
    v_exp_f32 v9, v9
    v_mov_b32 v13, 0
    v_add_f32 v9, 1.0, v9
    v_rcp_f32 v9, v9
    s_mov_b64 exec, vcc
    v_mul_f32 v9, v9, v8
    v_cvt_pk_bf16_f32 v10, v9, v9
    v_and_b32 v10, 0xffff, v10
    v_lshl_or_b32 v12, v10, 6, 1
    global_atomic_add_x2 v[14:15], v53, v[12:13], s[30:31] sc0 sc1
    s_mov_b64 exec, -1
L_f_nog:
    s_mov_b64 exec, s[42:43]
    s_cbranch_execz L_finish
    s_branch L_at_ret
L_fin:
    s_cmp_eq_u32 s6, 0
    s_cbranch_scc0 L_fin_ni
    v_mov_b32 v4, 0
    v_mov_b32 v5, 0
    v_add_u32 v1, 0xffff7f80, v54
    global_store_dwordx2 v54, v[4:5], s[30:31] sc1
    global_store_dwordx2 v1, v[4:5], s[30:31] sc1
L_fin_ni:
    s_mov_b32 s39, 160000
L_fy_w:
    ds_read_b32 v16, v63 offset:256
    s_sub_u32 s39, s39, 1
    s_cbranch_scc1 L_fy_ok
    s_waitcnt lgkmcnt(0)
    v_cmp_gt_u32 vcc, 1, v16
    s_nop 0
    s_cbranch_vccz L_fy_ok
    s_sleep 4
    s_branch L_fy_w
L_fy_ok:
    s_waitcnt lgkmcnt(0)
    v_readfirstlane_b32 s32, v16
    s_nop 0
    s_and_b32 s33, s32, 0xff8
    s_waitcnt vmcnt(0)
    s_cmp_eq_u32 s6, 0
    s_cbranch_scc0 L_fin_nj
    v_mov_b32 v4, s33
    v_mov_b32 v5, s33
    v_mov_b32 v6, s33
    v_mov_b32 v7, s33
    s_mov_b64 exec, 1
    global_store_dwordx4 v22, v[4:7], s[30:31] sc1
    s_mov_b64 exec, -1
L_fin_nj:
    s_mul_i32 s40, s34, 16
    s_add_u32 s40, s40, 120
    s_mov_b32 s39, 160000
L_fz_w:
    ds_read_b32 v16, v63 offset:0
    s_sub_u32 s39, s39, 1
    s_cbranch_scc1 L_fz_ok
    s_waitcnt lgkmcnt(0)
    v_cmp_gt_u32 vcc, s40, v16
    s_nop 0
    s_cbranch_vccz L_fz_ok
    s_sleep 4
    s_branch L_fz_w
L_fz_ok:
    s_waitcnt lgkmcnt(0)
    s_mov_b64 exec, 1
    s_mov_b32 s39, 20000
    global_load_dwordx4 v[64:67], v22, s[30:31] sc1
L_fl_poll:
    s_waitcnt vmcnt(0)
    v_xor_b32 v28, s33, v64
    v_xor_b32 v29, s33, v65
    v_xor_b32 v30, s33, v66
    v_xor_b32 v31, s33, v67
    v_or_b32 v16, v28, v29
    v_or3_b32 v16, v16, v30, v31
    v_and_b32 v16, 0xfff, v16
    v_cmp_ne_u32 vcc, 0, v16
    s_nop 0
    s_and_b64 exec, exec, vcc
    s_cbranch_scc0 L_fl_done
    global_load_dwordx4 v[64:67], v22, s[30:31] sc1
    s_sub_u32 s39, s39, 1
    s_cbranch_scc0 L_fl_poll
L_fl_done:
    s_mov_b64 exec, -1
    v_mov_b32 v20, 1
    v_lshlrev_b32 v23, 16, v23
    ds_write_b32 v63, v23 offset:9728
    ds_write_b32 v21, v20 offset:2176
    s_branch L_finish
L_kv:
    s_sub_u32 s5, s5, 4
    v_bfe_u32 v1, v0, 2, 2
    v_lshrrev_b32 v2, 4, v0
    v_mul_u32_u24 v3, 272, v1
    v_lshl_add_u32 v3, v2, 6, v3
    v_and_b32 v4, 3, v0
    v_xor_b32 v5, v4, v2
    v_lshlrev_b32 v5, 6, v5
    v_lshl_add_u32 v5, v4, 8, v5
    v_mul_u32_u24 v6, 1040, v1
    s_mul_i32 s40, s5, 8320
    s_add_u32 s40, s40, 43520
    v_add3_u32 v61, v5, v6, s40
    v_mul_u32_u24 v5, 320, v2
    v_and_b32 v6, 15, v0
    v_lshl_add_u32 v5, v6, 1, v5
    s_lshl_b32 s40, s5, 6
    v_add_u32 v54, s40, v5
    v_lshlrev_b32 v23, 4, v2
    s_lshl_b32 s40, s5, 2
    v_add_u32 v55, s40, v23
    v_mov_b32 v57, 1
    v_lshrrev_b32 v1, 5, v0
    v_bfe_u32 v2, v0, 4, 1
    v_lshl_add_u32 v4, v1, 3, v2
    v_mul_u32_u24 v4, 3456, v4
    v_and_b32 v5, 15, v0
    v_lshl_add_u32 v4, v5, 4, v4
    s_mul_i32 s40, s5, 6912
    s_add_u32 s40, s40, s36
    s_add_u32 s40, s40, 1051136
    v_add_u32 v58, s40, v4
    v_add_u32 v59, 55296, v58
    v_lshlrev_b32 v2, 7, v2
    v_and_b32 v4, 7, v0
    v_lshl_add_u32 v2, v4, 4, v2
    v_bfe_u32 v4, v0, 3, 1
    v_lshl_add_u32 v2, v4, 3, v2
    v_lshl_add_u32 v2, v1, 2, v2
    s_mul_i32 s40, s5, 272
    v_add_u32 v56, s40, v2
    s_mov_b32 s46, 0x3db504f3
    s_mov_b32 s47, 0x3fb8aa3b
    s_cmp_eq_u32 s5, 0
    s_cbranch_scc0 L_kv_npw
    s_lshl_b32 s42, s3, 10
    s_add_u32 s42, s42, 888832
    s_lshl_b32 s41, s4, 3
    s_add_u32 s41, s41, s42
    v_lshl_add_u32 v52, v23, 4, s41
    v_mov_b32 v50, 0x800
    v_mov_b32 v51, 0x800
    s_mov_b32 exec_lo, 0x10001
    s_mov_b32 exec_hi, 0x10001
    global_store_dwordx2 v52, v[50:51], s[48:49]
    s_mov_b32 exec_lo, 0x10001
    s_mov_b32 exec_hi, 0x10001
    global_load_dword v17, v52, s[48:49] nt
    s_mov_b64 exec, -1
    v_lshlrev_b32 v16, 3, v0
    v_mov_b32 v18, -3
    v_mov_b32 v19, -1
    ds_write_b64 v16, v[18:19] offset:4224
L_kv_npw:
    s_mul_i32 s45, s34, 16
    s_add_u32 s45, s45, 88
    s_lshl_b32 s40, s5, 3
    s_add_u32 s45, s45, s40
    s_mov_b32 s39, 160000
L_kp_w:
    ds_read_b32 v16, v63 offset:512
    s_sub_u32 s39, s39, 1
    s_cbranch_scc1 L_kp_ok
    s_waitcnt lgkmcnt(0)
    v_cmp_gt_u32 vcc, 1, v16
    s_nop 0
    s_cbranch_vccz L_kp_ok
    s_sleep 2
    s_branch L_kp_w
L_kp_ok:
    s_waitcnt lgkmcnt(0)
    v_readfirstlane_b32 s32, v16
    s_movk_i32 s57, 0xfff
    s_and_b32 s33, s32, 0xff8
    s_lshr_b32 s58, s32, 10
    s_and_b32 s38, s32, s57
    s_and_b32 s58, s58, 0x7f8
    s_xor_b32 s61, s58, s38
    s_xor_b32 s58, s58, s33
    s_waitcnt vmcnt(0)
    s_sleep 14
    s_cmp_eq_u32 s34, 0
    s_cbranch_scc1 L_q_np
    s_sleep 8
L_q_np:
    s_mov_b32 s39, 20000
    global_load_dwordx4 v[96:99], v58, s[30:31] sc1
    global_load_dwordx4 v[100:103], v59, s[30:31] sc1
L_q_poll:
    s_waitcnt vmcnt(1)
    v_xor_b32 v8, s38, v96
    v_xor_b32 v9, s38, v97
    v_xor_b32 v10, s61, v98
    v_xor_b32 v11, s61, v99
    v_or_b32 v4, v8, v9
    v_or3_b32 v4, v4, v10, v11
    s_waitcnt vmcnt(0)
    v_xor_b32 v12, s38, v100
    v_xor_b32 v13, s38, v101
    v_xor_b32 v14, s61, v102
    v_xor_b32 v15, s61, v103
    v_or3_b32 v4, v4, v12, v13
    v_or3_b32 v4, v4, v14, v15
    v_and_b32 v4, s57, v4
    v_cmp_ne_u32 vcc, 0, v4
    s_nop 0
    s_and_b64 exec, exec, vcc
    s_cbranch_scc0 L_q_done
    global_load_dwordx4 v[96:99], v58, s[30:31] sc1
    global_load_dwordx4 v[100:103], v59, s[30:31] sc1
    s_sub_u32 s39, s39, 1
    s_cbranch_scc1 L_q_done
    s_cmp_gt_u32 s39, 19976
    s_cbranch_scc1 L_q_poll
    v_xor_b32 v58, 0x100000, v58
    v_xor_b32 v59, 0x100000, v59
    s_cmp_lg_u32 s39, 19976
    s_cbranch_scc1 L_q_poll
    s_movk_i32 s57, 0xff8
    s_mov_b64 s[54:55], exec
    s_mov_b64 exec, -1
    v_mov_b32 v5, 0x1000
    ds_or_b32 v63, v5 offset:256
    s_mov_b64 exec, s[54:55]
    s_branch L_q_poll
L_q_clean:
    v_or_b32 v5, v8, v12
    v_and_b32 v5, 7, v5
    v_cmp_ne_u32 vcc, 0, v5
    s_nop 0
    s_cbranch_vccz L_q_same
    v_mov_b32 v5, 0x200000
    ds_or_b32 v63, v5 offset:256
L_q_same:
    v_and_b32 v8, v62, v8
    v_and_b32 v9, v62, v9
    v_and_b32 v10, v62, v10
    v_and_b32 v11, v62, v11
    v_and_b32 v12, v62, v12
    v_and_b32 v13, v62, v13
    v_and_b32 v14, v62, v14
    v_and_b32 v15, v62, v15
    s_branch L_q_cl
L_q_done:
    s_bitcmp0_b32 s57, 0
    s_mov_b64 exec, -1
    s_cbranch_scc1 L_q_clean
L_q_cl:
    s_setprio 2
    v_add_f32 v8, v8, v12
    v_add_f32 v9, v9, v13
    v_add_f32 v10, v10, v14
    v_add_f32 v11, v11, v15
    s_nop 0
    v_permlane32_swap_b32 v8, v10
    v_permlane32_swap_b32 v9, v11
    v_add_f32 v8, v8, v10
    v_add_f32 v9, v9, v11
    v_cvt_pk_bf16_f32 v8, v8, v9
    ds_write_b32 v56, v8 offset:3072
    ds_add_u32 v63, v57 offset:768
    s_mov_b32 s39, 160000
L_kk_w:
    ds_read_b32 v16, v63 offset:0
    s_sub_u32 s39, s39, 1
    s_cbranch_scc1 L_kk_ok
    s_waitcnt lgkmcnt(0)
    v_cmp_gt_u32 vcc, s45, v16
    s_nop 0
    s_cbranch_vccz L_kk_ok
    s_sleep 2
    s_branch L_kk_w
L_kk_ok:
    s_waitcnt lgkmcnt(0)
    ds_read_b128 v[64:67], v61 offset:0
    ds_read_b128 v[68:71], v61 offset:16
    ds_read_b128 v[72:75], v61 offset:32
    ds_read_b128 v[76:79], v61 offset:48
    ds_read_b128 v[80:83], v61 offset:4160
    ds_read_b128 v[84:87], v61 offset:4176
    ds_read_b128 v[88:91], v61 offset:4192
    ds_read_b128 v[92:95], v61 offset:4208
    s_mov_b32 s39, 160000
L_kq_w:
    ds_read_b32 v16, v63 offset:768
    s_sub_u32 s39, s39, 1
    s_cbranch_scc1 L_kq_ok
    s_waitcnt lgkmcnt(0)
    v_cmp_gt_u32 vcc, 4, v16
    s_nop 0
    s_cbranch_vccz L_kq_ok
    s_sleep 1
    s_branch L_kq_w
L_kq_ok:
    s_waitcnt lgkmcnt(0)
    ds_read_b128 v[28:31], v3 offset:3072
    ds_read_b128 v[32:35], v3 offset:3088
    ds_read_b128 v[36:39], v3 offset:3104
    ds_read_b128 v[40:43], v3 offset:3120
    s_waitcnt lgkmcnt(0)
    v_mfma_f32_16x16x32_bf16 v[8:11], v[28:31], v[64:67], 0
    v_mfma_f32_16x16x32_bf16 v[12:15], v[28:31], v[80:83], 0
    v_mfma_f32_16x16x32_bf16 v[8:11], v[32:35], v[68:71], v[8:11]
    v_mfma_f32_16x16x32_bf16 v[12:15], v[32:35], v[84:87], v[12:15]
    v_mfma_f32_16x16x32_bf16 v[8:11], v[36:39], v[72:75], v[8:11]
    v_mfma_f32_16x16x32_bf16 v[12:15], v[36:39], v[88:91], v[12:15]
    v_mfma_f32_16x16x32_bf16 v[8:11], v[40:43], v[76:79], v[8:11]
    v_mfma_f32_16x16x32_bf16 v[12:15], v[40:43], v[92:95], v[12:15]
    s_nop 7
    v_cvt_pk_bf16_f32 v16, v8, v12
    v_lshlrev_b32 v8, 16, v16
    v_and_b32 v9, 0xffff0000, v16
    v_mul_f32 v8, s46, v8
    v_mul_f32 v9, s46, v9
    v_cvt_pk_bf16_f32 v16, v8, v9
    v_lshlrev_b32 v8, 16, v16
    v_and_b32 v9, 0xffff0000, v16
    v_max_f32 v4, v8, v9
    s_nop 1
    v_max_f32_dpp v4, v4, v4 row_ror:1 row_mask:0xf bank_mask:0xf
    s_nop 1
    v_max_f32_dpp v4, v4, v4 row_ror:2 row_mask:0xf bank_mask:0xf
    s_nop 1
    v_max_f32_dpp v4, v4, v4 row_ror:4 row_mask:0xf bank_mask:0xf
    s_nop 1
    v_max_f32_dpp v4, v4, v4 row_ror:8 row_mask:0xf bank_mask:0xf
    v_sub_f32 v8, v8, v4
    v_sub_f32 v9, v9, v4
    ds_write_b32 v55, v4 offset:2048
    v_mul_f32 v8, s47, v8
    v_mul_f32 v9, s47, v9
    v_exp_f32 v8, v8
    v_exp_f32 v9, v9
    s_nop 0
    v_cvt_pk_bf16_f32 v10, v8, v9
    ds_write_b16 v54, v10 offset:8448
    ds_write_b16_d16_hi v54, v10 offset:8480
    ds_add_u32 v63, v57 offset:1280
    v_add_f32 v8, v8, v9
    s_nop 1
    v_add_f32_dpp v8, v8, v8 row_ror:1 row_mask:0xf bank_mask:0xf
    s_nop 1
    v_add_f32_dpp v8, v8, v8 row_ror:2 row_mask:0xf bank_mask:0xf
    s_nop 1
    v_add_f32_dpp v8, v8, v8 row_ror:4 row_mask:0xf bank_mask:0xf
    s_nop 1
    v_add_f32_dpp v8, v8, v8 row_ror:8 row_mask:0xf bank_mask:0xf
    ds_write_b32 v55, v8 offset:2112
    ds_add_rtn_u32 v5, v63, v57 offset:1024
    ds_read_b128 v[12:15], v23 offset:2112
    ds_read_b128 v[16:19], v23 offset:2048
    ds_read_b32 v7, v63 offset:256
    s_setprio 0
    s_lshl_b32 s42, s3, 10
    s_add_u32 s42, s42, 888832
    s_lshl_b32 s41, s4, 3
    s_add_u32 s41, s41, s42
    v_lshl_add_u32 v52, v23, 4, s41
    s_mov_b32 s56, 0
    s_lshl_b32 s41, s6, 8
    s_add_u32 s41, s41, s42
    s_add_u32 s41, s41, 1048576
    v_and_b32 v2, 31, v0
    v_lshl_add_u32 v58, v2, 3, s41
    v_bfe_u32 v2, v0, 2, 3
    v_mul_u32_u24 v2, 13824, v2
    v_lshrrev_b32 v6, 5, v0
    v_lshl_add_u32 v2, v6, 5, v2
    v_and_b32 v6, 3, v0
    v_lshl_add_u32 v2, v6, 3, v2
    s_lshl_b32 s41, s6, 8
    s_add_u32 s40, s36, s41
    s_lshl_b32 s41, s5, 6
    s_add_u32 s40, s40, s41
    s_add_u32 s40, s40, 1048576
    v_add_u32 v48, s40, v2
    v_add_u32 v49, 6912, v48
    s_waitcnt lgkmcnt(0)
    v_readfirstlane_b32 s60, v7
    v_cmp_eq_u32 vcc, 3, v5
    s_nop 0
    s_cbranch_vccz L_kv_noml
    v_max3_f32 v4, v16, v17, v18
    v_max_f32 v4, v4, v19
    v_sub_f32 v16, v16, v4
    v_sub_f32 v17, v17, v4
    v_sub_f32 v18, v18, v4
    v_sub_f32 v19, v19, v4
    v_mul_f32 v16, s47, v16
    v_mul_f32 v17, s47, v17
    v_mul_f32 v18, s47, v18
    v_mul_f32 v19, s47, v19
    v_exp_f32 v16, v16
    v_exp_f32 v17, v17
    v_exp_f32 v18, v18
    v_exp_f32 v19, v19
    v_mul_f32 v9, v12, v16
    v_fmac_f32 v9, v13, v17
    v_fmac_f32 v9, v14, v18
    v_fmac_f32 v9, v15, v19
    v_add_u32 v9, 0x800, v9
    v_and_or_b32 v50, v4, v62, s33
    v_and_or_b32 v51, v9, v62, s58
    s_mov_b32 exec_lo, 0x10001
    s_mov_b32 exec_hi, 0x10001
    s_mov_b32 s56, 1
    global_store_dwordx2 v52, v[50:51], s[48:49]
    s_bitcmp1_b32 s60, 12
    s_cbranch_scc0 L_kv_nsl
    global_store_dwordx2 v52, v[50:51], s[30:31] sc1
L_kv_nsl:
    s_mov_b64 exec, -1
L_kv_noml:
    s_lshr_b32 s40, s5, 1
    s_and_b32 s41, s5, 1
    s_lshl_b32 s40, s40, 13
    s_lshl_b32 s41, s41, 11
    s_add_u32 s40, s40, s41
    s_add_u32 s40, s40, 117760
    v_lshrrev_b32 v1, 4, v0
    v_bfe_u32 v2, v0, 2, 1
    v_bfe_u32 v3, v0, 3, 1
    v_and_b32 v4, 3, v0
    v_lshlrev_b32 v4, 3, v4
    v_lshl_add_u32 v4, v3, 7, v4
    v_lshl_add_u32 v4, v1, 9, v4
    v_mul_u32_u24 v2, 4160, v2
    v_and_b32 v3, 16, v0
    v_lshl_add_u32 v4, v3, 1, v4
    v_add3_u32 v40, v4, v2, s40
    v_xor_b32 v41, 32, v40
    v_xor_b32 v42, 64, v40
    v_xor_b32 v43, 0x60, v40
    v_lshlrev_b32 v56, 3, v0
    s_mov_b32 s50, 0xffff0000
    s_mov_b32 s51, s50
    s_mov_b32 s62, 0
    s_mov_b32 s63, -1
    v_lshrrev_b32 v1, 3, v0
    s_lshl_b32 s40, s7, 3
    v_add_u32 v1, s40, v1
    v_lshlrev_b32 v1, 8, v1
    v_and_b32 v53, 7, v0
    v_lshl_add_u32 v1, v53, 3, v1
    v_add_u32 v53, 917504, v1
    v_mov_b32 v55, 0
    s_lshl_b32 s40, s7, 7
    v_lshl_add_u32 v54, v0, 1, s40
    s_mov_b32 s52, 0
    s_mov_b32 s53, 0x41b80000
    s_mul_i32 s40, s34, 16
    s_add_u32 s40, s40, 144
    s_mov_b32 s39, 160000
L_km_w:
    ds_read_b32 v18, v63 offset:0
    s_sub_u32 s39, s39, 1
    s_cbranch_scc1 L_km_ok
    s_waitcnt lgkmcnt(0)
    v_cmp_gt_u32 vcc, s40, v18
    s_nop 0
    s_cbranch_vccz L_km_ok
    s_sleep 2
    s_branch L_km_w
L_km_ok:
    s_waitcnt lgkmcnt(0)
    global_load_dwordx2 v[80:81], v58, s[30:31] sc1
    s_mul_i32 s45, s34, 24
    s_add_u32 s45, s45, 152
    s_lshl_b32 s40, s5, 2
    s_and_b32 s40, s40, 8
    s_add_u32 s45, s45, s40
    s_mov_b32 s39, 160000
L_ko_w:
    ds_read_b32 v18, v63 offset:1536
    s_sub_u32 s39, s39, 1
    s_cbranch_scc1 L_ko_ok
    s_waitcnt lgkmcnt(0)
    v_cmp_gt_u32 vcc, 2, v18
    s_nop 0
    s_cbranch_vccz L_ko_ok
    s_sleep 1
    s_branch L_ko_w
L_ko_ok:
    s_waitcnt lgkmcnt(0)
    global_load_dwordx2 v[80:81], v58, s[30:31] sc1
    s_mul_i32 s40, s34, 24
    s_add_u32 s40, s40, 152
    s_mov_b32 s39, 160000
L_kb_w:
    ds_read_b32 v18, v63 offset:0
    s_sub_u32 s39, s39, 1
    s_cbranch_scc1 L_kb_ok
    s_waitcnt lgkmcnt(0)
    v_cmp_gt_u32 vcc, s40, v18
    s_nop 0
    s_cbranch_vccz L_kb_ok
    s_sleep 1
    s_branch L_kb_w
L_kb_ok:
    s_waitcnt lgkmcnt(0)
    s_setprio 2
    global_load_dwordx2 v[80:81], v58, s[30:31] sc1
    global_load_dwordx2 v[64:65], v48, s[30:31] offset:0 sc1
    global_load_dwordx2 v[66:67], v48, s[30:31] offset:3456 sc1
    global_load_dwordx2 v[68:69], v49, s[30:31] offset:0 sc1
    global_load_dwordx2 v[70:71], v49, s[30:31] offset:3456 sc1
    s_waitcnt vmcnt(6)
    v_xor_b32 v12, s33, v80
    v_xor_b32 v13, s58, v81
    v_or_b32 v4, v12, v13
    v_and_b32 v4, 0xfff, v4
    v_cmp_ne_u32 vcc, 0, v4
    s_nop 0
    s_cbranch_vccz L_ml_done
    s_waitcnt vmcnt(5)
    v_xor_b32 v12, s33, v80
    v_xor_b32 v13, s58, v81
    v_or_b32 v4, v12, v13
    v_and_b32 v4, 0xfff, v4
    v_cmp_ne_u32 vcc, 0, v4
    s_nop 0
    s_cbranch_vccz L_ml_done
    s_waitcnt vmcnt(4)
    v_xor_b32 v12, s33, v80
    v_xor_b32 v13, s58, v81
    v_or_b32 v4, v12, v13
    v_and_b32 v4, 0xfff, v4
    v_cmp_ne_u32 vcc, 0, v4
    s_nop 0
    s_cbranch_vccz L_ml_done
    s_mov_b32 s39, 20000
L_ml_poll:
    global_load_dwordx2 v[80:81], v58, s[30:31] sc1
    global_load_dwordx2 v[64:65], v48, s[30:31] offset:0 sc1
    global_load_dwordx2 v[66:67], v48, s[30:31] offset:3456 sc1
    global_load_dwordx2 v[68:69], v49, s[30:31] offset:0 sc1
    global_load_dwordx2 v[70:71], v49, s[30:31] offset:3456 sc1
    s_sub_u32 s39, s39, 1
    s_cbranch_scc1 L_ml_done
    s_cmp_gt_u32 s39, 19976
    s_cbranch_scc1 L_ml_nf
    v_xor_b32 v58, 0x100000, v58
L_ml_nf:
    s_waitcnt vmcnt(4)
    v_xor_b32 v12, s33, v80
    v_xor_b32 v13, s58, v81
    v_or_b32 v4, v12, v13
    v_and_b32 v4, 0xfff, v4
    v_cmp_ne_u32 vcc, 0, v4
    s_nop 0
    s_cbranch_vccnz L_ml_poll
L_ml_done:
    v_max_f32_dpp v4, v12, v12 quad_perm:[1,0,3,2] row_mask:0xf bank_mask:0xf
    s_nop 1
    v_max_f32_dpp v4, v4, v4 quad_perm:[2,3,0,1] row_mask:0xf bank_mask:0xf
    s_nop 1
    v_max_f32_dpp v4, v4, v4 row_ror:4 row_mask:0xf bank_mask:0xf
    s_nop 1
    v_max_f32_dpp v4, v4, v4 row_ror:8 row_mask:0xf bank_mask:0xf
    v_mov_b32 v5, v4
    s_nop 1
    v_permlane16_swap_b32 v4, v5
    v_max_f32 v4, v4, v5
    v_sub_f32 v12, v12, v4
    v_mul_f32 v12, s47, v12
    v_exp_f32 v12, v12
    s_nop 0
    v_mul_f32 v13, v12, v13
    s_nop 1
    v_add_f32_dpp v4, v13, v13 quad_perm:[1,0,3,2] row_mask:0xf bank_mask:0xf
    s_nop 1
    v_add_f32_dpp v4, v4, v4 quad_perm:[2,3,0,1] row_mask:0xf bank_mask:0xf
    s_nop 1
    v_add_f32_dpp v4, v4, v4 row_ror:4 row_mask:0xf bank_mask:0xf
    s_nop 1
    v_add_f32_dpp v4, v4, v4 row_ror:8 row_mask:0xf bank_mask:0xf
    v_mov_b32 v5, v4
    s_nop 1
    v_permlane16_swap_b32 v4, v5
    v_add_f32 v4, v4, v5
    v_rcp_f32 v4, v4
    s_nop 1
    v_mul_f32_dpp v44, v12, v4 quad_perm:[0,0,0,0] row_mask:0xf bank_mask:0xf
    v_mul_f32_dpp v45, v12, v4 quad_perm:[1,1,1,1] row_mask:0xf bank_mask:0xf
    v_mul_f32_dpp v46, v12, v4 quad_perm:[2,2,2,2] row_mask:0xf bank_mask:0xf
    v_mul_f32_dpp v47, v12, v4 quad_perm:[3,3,3,3] row_mask:0xf bank_mask:0xf
    s_bitcmp1_b32 s60, 21
    s_cbranch_scc1 L_b_slow
    s_mov_b32 s39, 20001
L_b_again:
    global_load_dwordx2 v[64:65], v48, s[30:31] offset:0 sc1
    global_load_dwordx2 v[66:67], v48, s[30:31] offset:3456 sc1
    global_load_dwordx2 v[68:69], v49, s[30:31] offset:0 sc1
    global_load_dwordx2 v[70:71], v49, s[30:31] offset:3456 sc1
    s_sub_u32 s39, s39, 1
    s_cbranch_scc0 L_b_poll
    s_branch L_b_done
L_b_slow:
    v_bfe_u32 v2, v0, 2, 3
    v_mul_u32_u24 v2, 13824, v2
    s_add_u32 s40, s36, 2097152
    v_lshlrev_b32 v48, 1, v48
    v_sub_u32 v48, v48, v2
    v_subrev_u32 v48, s40, v48
    v_add_u32 v49, 6912, v48
    s_mov_b32 s39, 20000
L_bs_poll:
    s_waitcnt vmcnt(0)
    global_load_dwordx4 v[64:67], v48, s[30:31] offset:0 sc1
    global_load_dwordx4 v[68:71], v48, s[30:31] offset:3456 sc1
    global_load_dwordx4 v[72:75], v49, s[30:31] offset:0 sc1
    global_load_dwordx4 v[76:79], v49, s[30:31] offset:3456 sc1
    ds_read_b32 v16, v63 offset:0
    ds_read_b32 v17, v55 offset:2176
    ds_read_b32 v19, v63 offset:9728
    ds_read_b64_tr_b16 v[112:113], v40 offset:0
    ds_read_b64_tr_b16 v[114:115], v40 offset:256
    ds_read_b64_tr_b16 v[116:117], v41 offset:0
    ds_read_b64_tr_b16 v[118:119], v41 offset:256
    ds_read_b64_tr_b16 v[120:121], v42 offset:0
    ds_read_b64_tr_b16 v[122:123], v42 offset:256
    ds_read_b64_tr_b16 v[124:125], v43 offset:0
    ds_read_b64_tr_b16 v[126:127], v43 offset:256
    s_waitcnt vmcnt(0)
    v_bitop3_b32 v5, v64, v65, s33 bitop3:0x7e
    v_bitop3_b32 v6, v66, v67, s58 bitop3:0x7e
    v_or_b32 v4, v5, v6
    v_pk_mul_f32 v[8:9], v[44:45], v[64:65] op_sel:[0,0] op_sel_hi:[0,1]
    v_pk_mul_f32 v[10:11], v[44:45], v[66:67] op_sel:[0,0] op_sel_hi:[0,1]
    v_bitop3_b32 v5, v68, v69, s33 bitop3:0x7e
    v_bitop3_b32 v6, v70, v71, s58 bitop3:0x7e
    v_or3_b32 v4, v4, v5, v6
    v_pk_fma_f32 v[8:9], v[44:45], v[68:69], v[8:9] op_sel:[1,0,0] op_sel_hi:[1,1,1]
    v_pk_fma_f32 v[10:11], v[44:45], v[70:71], v[10:11] op_sel:[1,0,0] op_sel_hi:[1,1,1]
    v_bitop3_b32 v5, v72, v73, s33 bitop3:0x7e
    v_bitop3_b32 v6, v74, v75, s58 bitop3:0x7e
    v_or3_b32 v4, v4, v5, v6
    v_pk_fma_f32 v[8:9], v[46:47], v[72:73], v[8:9] op_sel:[0,0,0] op_sel_hi:[0,1,1]
    v_pk_fma_f32 v[10:11], v[46:47], v[74:75], v[10:11] op_sel:[0,0,0] op_sel_hi:[0,1,1]
    v_bitop3_b32 v5, v76, v77, s33 bitop3:0x7e
    v_bitop3_b32 v6, v78, v79, s58 bitop3:0x7e
    v_or3_b32 v4, v4, v5, v6
    v_pk_fma_f32 v[8:9], v[46:47], v[76:77], v[8:9] op_sel:[1,0,0] op_sel_hi:[1,1,1]
    v_pk_fma_f32 v[10:11], v[46:47], v[78:79], v[10:11] op_sel:[1,0,0] op_sel_hi:[1,1,1]
    v_and_b32 v4, 0xfff, v4
    v_cmp_ne_u32 vcc, 0, v4
    s_sub_u32 s39, s39, 1
    s_cbranch_scc1 L_b_done
    s_cbranch_vccnz L_bs_poll
    s_branch L_b_done
L_wo_late:
    s_mov_b32 s39, 160000
L_wo_w:
    ds_read_b32 v16, v63 offset:0
    ds_read_b64_tr_b16 v[112:113], v40 offset:0
    ds_read_b64_tr_b16 v[114:115], v40 offset:256
    ds_read_b64_tr_b16 v[116:117], v41 offset:0
    ds_read_b64_tr_b16 v[118:119], v41 offset:256
    ds_read_b64_tr_b16 v[120:121], v42 offset:0
    ds_read_b64_tr_b16 v[122:123], v42 offset:256
    ds_read_b64_tr_b16 v[124:125], v43 offset:0
    ds_read_b64_tr_b16 v[126:127], v43 offset:256
    s_sub_u32 s39, s39, 1
    s_cbranch_scc1 L_wo_ok
    s_waitcnt lgkmcnt(0)
    v_cmp_gt_u32 vcc, s45, v16
    s_nop 0
    s_cbranch_vccnz L_wo_w
L_wo_ok:
    s_waitcnt lgkmcnt(0)
    v_mfma_f32_16x16x32_bf16 v[20:23], v[28:31], v[112:115], 0
    v_mfma_f32_16x16x32_bf16 v[24:27], v[28:31], v[116:119], 0
    v_mfma_f32_16x16x32_bf16 v[32:35], v[28:31], v[120:123], 0
    v_mfma_f32_16x16x32_bf16 v[36:39], v[28:31], v[124:127], 0
    s_branch L_wo_done
L_ki_late:
    s_mov_b32 s39, 160000
L_ki_w:
    ds_read_b32 v17, v55 offset:2176
    ds_read_b32 v19, v63 offset:9728
    s_sub_u32 s39, s39, 1
    s_cbranch_scc1 L_ki_ok
    s_waitcnt lgkmcnt(0)
    v_cmp_gt_u32 vcc, 1, v17
    s_nop 0
    s_cbranch_vccz L_ki_ok
    s_sleep 2
    s_branch L_ki_w
L_ki_ok:
    s_waitcnt lgkmcnt(0)
    s_branch L_at_go
L_b_poll:
    s_waitcnt vmcnt(7)
    s_mov_b64 s[54:55], exec
    s_mov_b64 exec, -1
    ds_read_b32 v16, v63 offset:0
    ds_read_b32 v17, v55 offset:2176
    ds_read_b32 v19, v63 offset:9728
    ds_read_b64_tr_b16 v[112:113], v40 offset:0
    ds_read_b64_tr_b16 v[114:115], v40 offset:256
    ds_read_b64_tr_b16 v[116:117], v41 offset:0
    ds_read_b64_tr_b16 v[118:119], v41 offset:256
    ds_read_b64_tr_b16 v[120:121], v42 offset:0
    ds_read_b64_tr_b16 v[122:123], v42 offset:256
    ds_read_b64_tr_b16 v[124:125], v43 offset:0
    ds_read_b64_tr_b16 v[126:127], v43 offset:256
    s_mov_b64 exec, s[54:55]
    v_max_u32 v4, v64, v65
    v_fma_mix_f32 v8, v64, v44, 0 op_sel:[0,0,0] op_sel_hi:[1,0,0]
    v_fma_mix_f32 v9, v64, v44, 0 op_sel:[1,0,0] op_sel_hi:[1,0,0]
    v_fma_mix_f32 v10, v65, v44, 0 op_sel:[0,0,0] op_sel_hi:[1,0,0]
    v_fma_mix_f32 v11, v65, v44, 0 op_sel:[1,0,0] op_sel_hi:[1,0,0]
    s_waitcnt vmcnt(6)
    v_max3_u32 v4, v4, v66, v67
    v_fma_mix_f32 v8, v66, v45, v8 op_sel:[0,0,0] op_sel_hi:[1,0,0]
    v_fma_mix_f32 v9, v66, v45, v9 op_sel:[1,0,0] op_sel_hi:[1,0,0]
    v_fma_mix_f32 v10, v67, v45, v10 op_sel:[0,0,0] op_sel_hi:[1,0,0]
    v_fma_mix_f32 v11, v67, v45, v11 op_sel:[1,0,0] op_sel_hi:[1,0,0]
    s_waitcnt vmcnt(5)
    v_max3_u32 v4, v4, v68, v69
    v_fma_mix_f32 v8, v68, v46, v8 op_sel:[0,0,0] op_sel_hi:[1,0,0]
    v_fma_mix_f32 v9, v68, v46, v9 op_sel:[1,0,0] op_sel_hi:[1,0,0]
    v_fma_mix_f32 v10, v69, v46, v10 op_sel:[0,0,0] op_sel_hi:[1,0,0]
    v_fma_mix_f32 v11, v69, v46, v11 op_sel:[1,0,0] op_sel_hi:[1,0,0]
    s_waitcnt vmcnt(4)
    v_max3_u32 v4, v4, v70, v71
    v_cmp_eq_u32 vcc, -1, v4
    v_fma_mix_f32 v8, v70, v47, v8 op_sel:[0,0,0] op_sel_hi:[1,0,0]
    v_fma_mix_f32 v9, v70, v47, v9 op_sel:[1,0,0] op_sel_hi:[1,0,0]
    v_fma_mix_f32 v10, v71, v47, v10 op_sel:[0,0,0] op_sel_hi:[1,0,0]
    v_fma_mix_f32 v11, v71, v47, v11 op_sel:[1,0,0] op_sel_hi:[1,0,0]
    s_and_b64 exec, exec, vcc
    s_cbranch_scc1 L_b_again
L_b_done:
    s_mov_b64 exec, -1
    v_permlane16_swap_b32 v8, v9
    v_permlane16_swap_b32 v10, v11
    v_add_f32 v8, v8, v9
    v_add_f32 v10, v10, v11
    s_nop 0
    v_add_f32_dpp v8, v8, v8 row_ror:4 row_mask:0xf bank_mask:0xf
    v_add_f32_dpp v10, v10, v10 row_ror:4 row_mask:0xf bank_mask:0xf
    s_nop 0
    v_add_f32_dpp v8, v8, v8 row_ror:8 row_mask:0xf bank_mask:0xf
    v_add_f32_dpp v10, v10, v10 row_ror:8 row_mask:0xf bank_mask:0xf
    v_cvt_pk_bf16_f32 v8, v8, v10
    s_waitcnt lgkmcnt(0)
    v_cmp_gt_u32 vcc, s45, v16
    v_mov_b32_dpp v28, v8 quad_perm:[0,0,0,0] row_mask:0xf bank_mask:0xf
    v_mov_b32_dpp v29, v8 quad_perm:[1,1,1,1] row_mask:0xf bank_mask:0xf
    v_mov_b32_dpp v30, v8 quad_perm:[2,2,2,2] row_mask:0xf bank_mask:0xf
    v_mov_b32_dpp v31, v8 quad_perm:[3,3,3,3] row_mask:0xf bank_mask:0xf
    v_cmp_eq_u32 s[42:43], 0, v17
    s_cbranch_vccnz L_wo_late
    v_mfma_f32_16x16x32_bf16 v[20:23], v[28:31], v[112:115], 0
    v_mfma_f32_16x16x32_bf16 v[24:27], v[28:31], v[116:119], 0
    v_mfma_f32_16x16x32_bf16 v[32:35], v[28:31], v[120:123], 0
    v_mfma_f32_16x16x32_bf16 v[36:39], v[28:31], v[124:127], 0
L_wo_done:
    s_cmp_eq_u64 s[42:43], 0
    s_nop 4
    v_cndmask_b32 v20, v20, v24, s[50:51]
    s_nop 0
    v_cndmask_b32 v32, v32, v36, s[50:51]
    v_cndmask_b32 v8, v20, v32, s[62:63]
    v_cvt_f64_f32 v[14:15], v8
    v_add_f64 v[14:15], v[14:15], s[52:53]
    v_lshl_or_b32 v12, v14, 22, 1
    v_alignbit_b32 v13, v15, v14, 10
    ds_add_rtn_u64 v[14:15], v56, v[12:13] offset:4224
    s_cbranch_scc0 L_ki_late
L_at_go:
    s_waitcnt lgkmcnt(0)
    v_cmp_eq_u16 vcc, 0, v14
    v_lshl_add_u64 v[12:13], v[12:13], 0, v[14:15]
    s_and_b64 exec, exec, vcc
    s_cbranch_scc0 L_kv_end
    global_atomic_add_x2 v[14:15], v53, v[12:13], s[30:31] sc0 sc1
L_at_ret:
    s_waitcnt vmcnt(0)
    v_lshl_add_u64 v[12:13], v[12:13], 0, v[14:15]
    v_lshrrev_b32 v9, 22, v12
    v_cvt_f32_i32 v8, v13
    v_cvt_f32_u32 v9, v9
    v_lshlrev_b32 v18, 10, v12
    v_fmac_f32 v8, 0x3a800000, v9
    v_and_b32 v18, 0xffff0000, v18
    v_cvt_pk_bf16_f32 v8, 0, v8
    v_and_b32 v10, 63, v12
    v_mul_f32 v8, v8, v18
    v_cmp_eq_u32 vcc, 33, v10
    v_cvt_pk_bf16_f32 v8, 0, v8
    v_fmac_f32 v19, 0x38800000, v8
    s_and_b64 exec, exec, vcc
    v_cvt_pk_bf16_f32 v8, v19, v19
    s_cbranch_scc0 L_kv_end
    global_store_short v54, v8, s[26:27]
    v_cmp_eq_u32 vcc, 0, v54
    v_mov_b32 v2, s32
    s_and_b64 exec, exec, vcc
    s_cbranch_scc0 L_kv_end
    global_store_dword v54, v2, s[30:31]
L_kv_end:
L_finish:
    s_waitcnt lgkmcnt(0)
L_exit:
    s_endpgm
    .fill 128, 4, 0xbf810000
.section .rodata,"a"
.p2align 6
.amdhsa_kernel recurrent_scan__sliding_block_cached__geglu_ffn__decode_kernel
  .amdhsa_next_free_vgpr 128
  .amdhsa_next_free_sgpr 96
  .amdhsa_accum_offset 128
  .amdhsa_group_segment_fixed_size 0
  .amdhsa_kernarg_size 96
  .amdhsa_user_sgpr_count 2
  .amdhsa_user_sgpr_kernarg_segment_ptr 1
  .amdhsa_system_sgpr_workgroup_id_x 1
  .amdhsa_float_denorm_mode_32 3
.end_amdhsa_kernel
```
